```python
import torch

def _softmax(x, axis=-1):
    return torch.softmax(x, dim=axis)
def _gelu(x):
    return torch.nn.functional.gelu(x, approximate="tanh")
def _silu(x):
    return torch.nn.functional.silu(x)
def _sigmoid(x):
    return torch.sigmoid(x)
def _layernorm(x, axis=-1, eps=1e-5):
    m = x.mean(dim=axis, keepdim=True)
    v = x.var(dim=axis, keepdim=True, unbiased=False)
    return (x - m) / torch.sqrt(v + eps)
def _scatter_add(tgt, idx, src, axis=0):
    return tgt.clone().index_add_(axis, idx, src)
def _segment_sum(src, seg, n):
    out = torch.zeros((n,) + src.shape[1:], dtype=src.dtype)
    return out.index_add_(0, seg, src)
def _pad(x, pw):
    flat = tuple(v for pair in reversed(pw) for v in pair)
    return torch.nn.functional.pad(x, flat)

kernel_name = 'sequential_preLN__ssm_conv_h3__geglu_ffn__prompt'

def setup_inputs():

    _w = (lambda a: (lambda t: t.to(torch.bfloat16) if t.is_floating_point() else t)(torch.as_tensor(a)))
    def _A_setup():
        B, S, D = 1, 2048, 448
        ks = 4
        return {
            "q": _w((lambda *s: torch.randn(*s, dtype=torch.bfloat16) * 0.05)(B, S, D)),
            "k": _w((lambda *s: torch.randn(*s, dtype=torch.bfloat16) * 0.4)(B, S, D)),
            "v": _w((lambda *s: torch.randn(*s, dtype=torch.bfloat16) * 0.4)(B, S, D)),
            "shift_k": _w((lambda *s: torch.randn(*s, dtype=torch.bfloat16) * 0.4)(D, ks) * 0.5),
            "ssm_k": _w((lambda *s: torch.randn(*s, dtype=torch.bfloat16) * 0.4)(D, S) * (1.0 / S ** 0.5)),
            "ssm_D": _w((lambda *s: torch.randn(*s, dtype=torch.bfloat16) * 0.4)(D)),
        }
    _A_in = _A_setup()

    def _B_setup():
        B, S, D, F = 1, 2048, 448, 1792
        return {
            "x": _w((lambda *s: torch.randn(*s, dtype=torch.bfloat16) * 0.05)(B, S, D)),
            "w_gate": _w((lambda *s: torch.randn(*s, dtype=torch.bfloat16) * 0.05)(D, F)),
            "w_up": _w((lambda *s: torch.randn(*s, dtype=torch.bfloat16) * 0.05)(D, F)),
            "w_down": _w((lambda *s: torch.randn(*s, dtype=torch.bfloat16) * 0.05)(F, D)),
        }
    _B_in = _B_setup()

    return {
        "A_q": _A_in["q"],
        "A_k": _A_in["k"],
        "A_v": _A_in["v"],
        "A_shift_k": _A_in["shift_k"],
        "A_ssm_k": _A_in["ssm_k"],
        "A_ssm_D": _A_in["ssm_D"],
        "B_x": _B_in["x"],
        "B_w_gate": _B_in["w_gate"],
        "B_w_up": _B_in["w_up"],
        "B_w_down": _B_in["w_down"],
    }

def reference(A_q, A_k, A_v, A_shift_k, A_ssm_k, A_ssm_D, B_x, B_w_gate, B_w_up, B_w_down):
    def _A_ref(q, k, v, shift_k, ssm_k, ssm_D):
        B, S, D = q.shape
        ks = shift_k.shape[-1]
        k_pad = _pad(k, ((0, 0), (ks - 1, 0), (0, 0)))
        k_shift = torch.zeros_like(k)
        for t in range(ks):
            k_shift = k_shift + k_pad[:, t:t + S, :] * shift_k[:, ks - 1 - t][None, None, :]
        kv = k_shift * v
        L = 2 * S
        kv_pad = _pad(kv, ((0, 0), (0, S), (0, 0)))
        kf_pad = _pad(ssm_k, ((0, 0), (0, S)))
        kv_f = (lambda x, axes=(-2,-1): torch.fft.rfft2(x.float(), dim=axes))(kv_pad[:, None, :, :], axes=(1, 2))
        kf_f = (lambda x, axes=(-2,-1): torch.fft.rfft2(x.float(), dim=axes))(kf_pad[:, None, :], axes=(1, 2))
        kf_f = (lambda x, *d: x.permute(*d))(kf_f, 1, 2, 0)
        y_f = kv_f * kf_f[None, :, :, :]
        y = (lambda x, s, axes=(-2,-1): torch.fft.irfft2(x, s=s, dim=axes).to(torch.bfloat16))(y_f, (1, L), axes=(1, 2))[:, 0, :S, :]
        y = y + kv * ssm_D[None, None, :]
        return q * y

    def _B_ref(x, w_gate, w_up, w_down):
        return (_gelu(x @ w_gate) * (x @ w_up)) @ w_down

    x = A_q
    h = x + _A_ref(_layernorm(x, axis=-1), A_k, A_v, A_shift_k, A_ssm_k, A_ssm_D)
    h2 = h + _B_ref(_layernorm(h, axis=-1), B_w_gate, B_w_up, B_w_down)
    return h2
```

```asm
; @launch grid=(256,1,1) block=(512,1,1) lds=163840
.amdgcn_target "amdgcn-amd-amdhsa--gfx950"
.text
.globl sequential_preLN__ssm_conv_h3__geglu_ffn__prompt_kernel
.p2align 8
.type sequential_preLN__ssm_conv_h3__geglu_ffn__prompt_kernel,@function
sequential_preLN__ssm_conv_h3__geglu_ffn__prompt_kernel:
    s_cmp_ge_u32 s2, 256
    s_cbranch_scc1 La_end
    s_load_dwordx8 s[4:11], s[0:1], 0
    s_load_dwordx4 s[12:15], s[0:1], 32
    s_load_dwordx4 s[48:51], s[0:1], 88
    s_load_dwordx4 s[40:43], s[0:1], 56
    s_load_dwordx4 s[44:47], s[0:1], 72
    v_and_b32 v1, 63, v0
    v_lshrrev_b32 v2, 6, v0
    v_lshrrev_b32 v3, 3, v1
    v_and_b32 v4, 7, v1
    v_readfirstlane_b32 s36, v2
    v_mov_b32 v17, 0
    s_cmp_lt_u32 s2, 32
    s_cbranch_scc1 La_help
    s_sub_u32 s37, s2, 32
    s_mul_i32 s39, s37, 293
    s_lshr_b32 s39, s39, 11
    s_mul_i32 s38, s39, 7
    s_sub_u32 s38, s37, s38
    v_xor_b32 v5, v4, v2
    v_lshlrev_b32 v5, 4, v5
    v_mov_b32 v6, 896
    v_mad_u32_u24 v5, v3, v6, v5
    s_mul_i32 s56, s39, 57344
    s_lshl_b32 s57, s38, 7
    s_add_u32 s56, s56, s57
    s_mul_i32 s57, s36, 7168
    s_add_u32 s57, s57, s56
    s_sub_u32 s58, s56, 7168
    v_add_u32 v6, s58, v5
    s_lshl_b32 s60, s36, 10
    v_lshrrev_b32 v7, 4, v0
    s_lshl_b32 s61, s38, 6
    v_lshl_add_u32 v8, v7, 1, s61
    v_lshlrev_b32 v9, 3, v8
    s_lshl_b32 s62, s39, 1
    s_add_u32 s62, s62, s61
    s_lshr_b32 s35, s36, 2
    s_add_u32 s3, s62, s35
    s_lshl_b32 s3, s3, 12
    v_and_b32 v10, 255, v0
    v_lshlrev_b32 v10, 4, v10
    v_subrev_u32 v11, 4, v10
    s_waitcnt lgkmcnt(0)
    s_mov_b32 s20, s6
    s_mov_b32 s21, s7
    s_mov_b32 s22, 0x1c0000
    s_mov_b32 s23, 0x20000
    s_add_u32 m0, s60, 132352
    s_mov_b32 s24, s8
    s_mov_b32 s25, s9
    s_mov_b32 s26, 0x1c0000
    s_mov_b32 s27, 0x20000
    buffer_load_dwordx4 v5, s[20:23], s57 offen lds
    s_add_u32 m0, s60, 140544
    s_mov_b32 s28, s4
    s_mov_b32 s29, s5
    s_mov_b32 s30, 0x1c0000
    s_mov_b32 s31, 0x20000
    buffer_load_dwordx4 v5, s[24:27], s57 offen lds
    s_add_u32 m0, s60, 148736
    s_cmp_lg_u32 s36, 7
    buffer_load_dwordx4 v5, s[28:31], s57 offen lds
    s_cbranch_scc1 La_nohalo
    s_mov_b32 m0, 131328
    s_nop 0
    buffer_load_dwordx4 v6, s[20:23], 0 offen lds
La_nohalo:
    s_mov_b32 s24, s10
    s_mov_b32 s25, s11
    s_mov_b32 s26, 0xe00
    s_mov_b32 s27, 0x20000
    buffer_load_dwordx4 v[40:43], v9, s[24:27], 0 offen
    s_add_u32 s20, s12, s3
    s_addc_u32 s21, s13, 0
    s_mov_b32 s22, 4096
    s_mov_b32 s23, 0x20000
    buffer_load_dwordx4 v[112:115], v10, s[20:23], 0 offen
    buffer_load_dword v111, v11, s[20:23], 0 offen
    s_lshl_b32 s3, s62, 1
    s_add_u32 s14, s14, s3
    s_addc_u32 s15, s15, 0
    s_load_dword s34, s[14:15], 0
    s_mov_b32 s16, s50
    s_mov_b32 s17, s51
    s_mov_b32 s18, 0x1440000
    s_mov_b32 s19, 0x20000
    s_mov_b32 s52, s48
    s_mov_b32 s53, s49
    s_mov_b32 s54, 0x100
    s_mov_b32 s55, 0x20000
    s_mov_b32 s24, s40
    s_mov_b32 s25, s41
    s_mov_b32 s26, 0x188000
    s_mov_b32 s27, 0x20000
    s_mov_b32 s28, s42
    s_mov_b32 s29, s43
    s_mov_b32 s30, 0x188000
    s_mov_b32 s31, 0x20000
    s_and_b32 s3, s37, 7
    s_lshr_b32 s9, s37, 3
    s_cmp_ge_u32 s9, 14
    s_cselect_b32 s10, 1, 0
    s_mul_i32 s5, s10, 14
    s_sub_u32 s5, s9, s5
    s_and_b32 s4, s3, 6
    s_add_u32 s4, s4, s10
    s_and_b32 s3, s3, 1
    s_mul_i32 s3, s3, 14
    s_add_u32 s5, s5, s3
    s_mul_i32 s7, s5, 37
    s_lshr_b32 s7, s7, 8
    s_mul_i32 s6, s7, 7
    s_sub_u32 s6, s5, s6
    v_and_b32 v2, 2, v3
    v_xor_b32 v2, v2, v4
    v_lshlrev_b32 v2, 4, v2
    v_mov_b32 v9, 3584
    v_mad_u32_u24 v2, v3, v9, v2
    v_xor_b32 v5, 64, v2
    s_mul_i32 s8, s36, 28672
    s_lshl_b32 s3, s5, 7
    s_add_u32 s8, s8, s3
    s_lshl_b32 s9, s35, 12
    s_add_u32 s9, s9, s60
    s_add_u32 m0, s9, 0
    s_nop 0
    buffer_load_dwordx4 v2, s[24:27], s8 offen lds
    s_add_u32 m0, s9, 4096
    s_nop 0
    buffer_load_dwordx4 v5, s[28:31], s8 offen lds
    s_add_u32 s8, s8, 229376
    v_bfe_u32 v9, v1, 3, 2
    s_and_b32 s3, s36, 3
    v_xor_b32 v9, s3, v9
    v_lshlrev_b32 v21, 5, v9
    v_bfe_u32 v9, v1, 4, 1
    v_lshl_add_u32 v21, v9, 12, v21
    v_bfe_u32 v20, v1, 2, 2
    v_lshrrev_b32 v9, 5, v1
    v_lshl_add_u32 v9, v9, 3, v20
    v_lshl_add_u32 v21, v9, 7, v21
    v_and_b32 v9, 1, v1
    v_lshl_add_u32 v21, v9, 4, v21
    v_and_b32 v9, 2, v1
    v_lshl_add_u32 v6, v9, 2, v21
    v_and_b32 v12, 15, v1
    v_and_b32 v14, 3, v7
    v_lshlrev_b32 v14, 2, v14
    v_lshl_add_u32 v14, v12, 9, v14
    v_lshrrev_b32 v13, 1, v12
    v_xor_b32 v13, s36, v13
    v_lshl_add_u32 v13, v13, 4, v14
    v_add_u32 v13, 132352, v13
    v_add_u32 v15, 15, v12
    v_bfe_u32 v15, v15, 1, 3
    v_xor_b32 v15, s36, v15
    v_lshl_add_u32 v15, v15, 4, v14
    v_add_u32 v15, 131840, v15
    v_add_u32 v45, 8192, v13
    v_add_u32 v47, 16384, v13
    v_mul_u32_u24 v46, 12288, v8
    v_lshl_add_u32 v46, v12, 4, v46
    s_lshl_b32 s58, s39, 8
    s_add_u32 s58, s58, 0xf00000
    s_mul_i32 s3, s35, 8320
    s_add_u32 s3, s3, 114688
    v_add_u32 v10, s3, v10
    v_mov_b32 v96, 0
    v_mov_b32 v97, 0
    v_mov_b32 v98, 0
    v_mov_b32 v99, 0
    v_cmp_gt_i32 vcc, 16, v11
    s_nop 0
    s_and_saveexec_b64 s[56:57], vcc
    s_cbranch_execz La_nz
    ds_write_b128 v10, v[96:99]
    ds_write_b128 v10, v[96:99] offset:4160
La_nz:
    s_mov_b64 exec, s[56:57]
    s_mov_b32 s32, 0x05040100
    s_mov_b32 s33, 0x07060302
    s_waitcnt vmcnt(4)
    buffer_load_dword v12, v17, s[52:55], 0 offen sc1
    v_lshlrev_b32 v72, 16, v40
    v_lshlrev_b32 v73, 16, v42
    v_and_b32 v74, 0xffff0000, v40
    v_and_b32 v75, 0xffff0000, v42
    v_lshlrev_b32 v76, 16, v41
    v_lshlrev_b32 v77, 16, v43
    v_and_b32 v78, 0xffff0000, v41
    v_and_b32 v79, 0xffff0000, v43
    s_waitcnt lgkmcnt(0)
    s_barrier
    ds_read_b32 v19, v15 offset:128
    ds_read2_b32 v[20:21], v15 offset0:64 offset1:96
    ds_read2_b32 v[22:23], v13 offset0:0 offset1:32
    ds_read2_b32 v[24:25], v13 offset0:64 offset1:96
    ds_read2_b32 v[26:27], v45 offset0:0 offset1:32
    ds_read2_b32 v[28:29], v45 offset0:64 offset1:96
    ds_read2_b32 v[30:31], v47 offset0:0 offset1:32
    ds_read2_b32 v[32:33], v47 offset0:64 offset1:96
    s_waitcnt lgkmcnt(4)
    v_lshlrev_b32 v50, 16, v19
    v_and_b32 v51, 0xffff0000, v19
    v_lshlrev_b32 v52, 16, v20
    v_and_b32 v53, 0xffff0000, v20
    v_lshlrev_b32 v54, 16, v21
    v_and_b32 v55, 0xffff0000, v21
    v_lshlrev_b32 v56, 16, v22
    v_and_b32 v57, 0xffff0000, v22
    v_lshlrev_b32 v58, 16, v23
    v_and_b32 v59, 0xffff0000, v23
    v_lshlrev_b32 v60, 16, v24
    v_and_b32 v61, 0xffff0000, v24
    v_lshlrev_b32 v62, 16, v25
    v_and_b32 v63, 0xffff0000, v25
    v_pk_mul_f32 v[80:81], v[50:51], v[78:79]
    v_pk_mul_f32 v[82:83], v[52:53], v[78:79]
    v_pk_mul_f32 v[84:85], v[54:55], v[78:79]
    v_pk_mul_f32 v[86:87], v[56:57], v[78:79]
    v_pk_fma_f32 v[80:81], v[52:53], v[76:77], v[80:81]
    v_pk_fma_f32 v[82:83], v[54:55], v[76:77], v[82:83]
    v_pk_fma_f32 v[84:85], v[56:57], v[76:77], v[84:85]
    v_pk_fma_f32 v[86:87], v[58:59], v[76:77], v[86:87]
    v_pk_fma_f32 v[80:81], v[54:55], v[74:75], v[80:81]
    v_pk_fma_f32 v[82:83], v[56:57], v[74:75], v[82:83]
    v_pk_fma_f32 v[84:85], v[58:59], v[74:75], v[84:85]
    v_pk_fma_f32 v[86:87], v[60:61], v[74:75], v[86:87]
    v_pk_fma_f32 v[80:81], v[56:57], v[72:73], v[80:81]
    v_pk_fma_f32 v[82:83], v[58:59], v[72:73], v[82:83]
    v_pk_fma_f32 v[84:85], v[60:61], v[72:73], v[84:85]
    v_pk_fma_f32 v[86:87], v[62:63], v[72:73], v[86:87]
    s_waitcnt lgkmcnt(0)
    v_lshlrev_b32 v50, 16, v26
    v_and_b32 v51, 0xffff0000, v26
    v_lshlrev_b32 v52, 16, v27
    v_and_b32 v53, 0xffff0000, v27
    v_lshlrev_b32 v54, 16, v28
    v_and_b32 v55, 0xffff0000, v28
    v_lshlrev_b32 v56, 16, v29
    v_and_b32 v57, 0xffff0000, v29
    v_pk_mul_f32 v[80:81], v[80:81], v[50:51]
    v_pk_mul_f32 v[82:83], v[82:83], v[52:53]
    v_pk_mul_f32 v[84:85], v[84:85], v[54:55]
    v_pk_mul_f32 v[86:87], v[86:87], v[56:57]
    v_perm_b32 v122, v31, v30, s32
    v_perm_b32 v126, v33, v32, s32
    v_perm_b32 v36, v31, v30, s33
    v_perm_b32 v37, v33, v32, s33
    v_cvt_pk_bf16_f32 v120, v86, v84
    v_cvt_pk_bf16_f32 v121, v82, v80
    v_cvt_pk_bf16_f32 v124, v87, v85
    v_cvt_pk_bf16_f32 v125, v83, v81
    s_waitcnt vmcnt(0)
    s_mov_b32 s59, 0
La_nc:
    v_readfirstlane_b32 s63, v12
    s_nop 0
    s_cmp_lg_u32 s63, 0
    s_cbranch_scc1 La_ngo
    s_cmp_gt_u32 s59, 262144
    s_cbranch_scc1 La_ngo
    buffer_load_dword v12, v17, s[52:55], 0 offen sc1
    s_add_u32 s59, s59, 1
    s_waitcnt vmcnt(0)
    s_branch La_nc
La_ngo:
    v_mov_b32 v123, s63
    buffer_store_dwordx4 v[120:123], v46, s[16:19], s58 offen sc1
    s_add_u32 s58, s58, 8192
    v_mov_b32 v127, s63
    buffer_store_dwordx4 v[124:127], v46, s[16:19], s58 offen sc1
    s_add_u32 s58, s58, 8192
    v_mov_b32 v39, s63
    buffer_store_dwordx4 v[36:39], v46, s[16:19], s58 offen sc1
    s_lshr_b32 s3, s34, 16
    s_cmp_eq_u32 s35, 0
    s_cselect_b32 s34, s34, s3
    s_lshl_b32 s34, s34, 16
    v_lshlrev_b32 v116, 16, v112
    v_and_b32 v117, 0xffff0000, v112
    v_add_f32 v116, s34, v116
    v_cmp_gt_i32 vcc, 0, v11
    v_cvt_pk_bf16_f32 v116, v116, v117
    s_nop 0
    v_cndmask_b32 v112, v112, v116, vcc
    ds_write_b128 v10, v[112:115] offset:32
    v_alignbit_b32 v116, v112, v111, 16
    v_alignbit_b32 v117, v113, v112, 16
    v_alignbit_b32 v118, v114, v113, 16
    v_alignbit_b32 v119, v115, v114, 16
    ds_write_b128 v10, v[116:119] offset:4192
    s_waitcnt lgkmcnt(0)
    s_barrier
    v_lshlrev_b32 v19, 4, v1
    v_add_u32 v20, 151808, v19
    v_cmp_gt_u32 vcc, 30, v0
    s_nop 0
    s_and_saveexec_b64 s[32:33], vcc
    s_cbranch_execz La_nz2
    ds_write_b128 v20, v[96:99]
    ds_write_b128 v20, v[96:99] offset:4608
La_nz2:
    s_mov_b64 exec, s[32:33]
    v_and_b32 v3, 15, v1
    v_lshrrev_b32 v4, 4, v1
    s_and_b32 s32, s36, 1
    s_bfe_u32 s33, s36, 0x10001
    s_mul_i32 s3, s33, 4608
    s_add_u32 s14, s3, 147712
    s_lshl_b32 s15, s32, 6
    s_add_u32 s3, s14, s15
    s_add_u32 s3, s3, 480
    v_lshlrev_b32 v12, 5, v3
    v_sub_u32 v12, s3, v12
    v_lshl_add_u32 v12, v4, 4, v12
    v_add_u32 v13, 1, v3
    v_and_b32 v14, 1, v13
    v_lshrrev_b32 v13, 1, v13
    v_lshl_add_u32 v13, v4, 2, v13
    v_mul_u32_u24 v14, 4164, v14
    v_lshl_add_u32 v13, v13, 2, v14
    s_mul_i32 s3, s33, 8320
    s_add_u32 s3, s3, s15
    s_add_u32 s3, s3, 114688
    v_add_u32 v13, s3, v13
    v_add_u32 v14, 1024, v13
    v_add_u32 v15, 2048, v13
    v_add_u32 v16, 3072, v13
    s_cmp_ge_u32 s36, 4
    s_cbranch_scc1 La_ch
    s_waitcnt lgkmcnt(0)
    ds_read2_b32 v[72:73], v13 offset0:0 offset1:1
    ds_read2_b32 v[74:75], v13 offset0:2 offset1:3
    ds_read2_b32 v[76:77], v13 offset0:32 offset1:33
    ds_read2_b32 v[78:79], v13 offset0:34 offset1:35
    ds_read2_b32 v[80:81], v13 offset0:64 offset1:65
    ds_read2_b32 v[82:83], v13 offset0:66 offset1:67
    ds_read2_b32 v[84:85], v13 offset0:96 offset1:97
    ds_read2_b32 v[86:87], v13 offset0:98 offset1:99
    ds_read2_b32 v[88:89], v13 offset0:128 offset1:129
    ds_read2_b32 v[90:91], v13 offset0:130 offset1:131
    ds_read2_b32 v[92:93], v13 offset0:160 offset1:161
    ds_read2_b32 v[94:95], v13 offset0:162 offset1:163
    ds_read2_b32 v[96:97], v13 offset0:192 offset1:193
    ds_read2_b32 v[98:99], v13 offset0:194 offset1:195
    ds_read2_b32 v[100:101], v13 offset0:224 offset1:225
    s_waitcnt lgkmcnt(11)
    ds_read2_b32 v[102:103], v13 offset0:226 offset1:227
    ds_read2_b32 v[104:105], v14 offset0:0 offset1:1
    ds_read2_b32 v[106:107], v14 offset0:2 offset1:3
    ds_read2_b32 v[108:109], v14 offset0:32 offset1:33
    s_waitcnt lgkmcnt(11)
    ds_read2_b32 v[110:111], v14 offset0:34 offset1:35
    ds_read2_b32 v[112:113], v14 offset0:64 offset1:65
    ds_read2_b32 v[114:115], v14 offset0:66 offset1:67
    ds_read2_b32 v[116:117], v14 offset0:96 offset1:97
    s_waitcnt lgkmcnt(11)
    ds_read2_b32 v[118:119], v14 offset0:98 offset1:99
    ds_read2_b32 v[120:121], v14 offset0:128 offset1:129
    ds_read2_b32 v[122:123], v14 offset0:130 offset1:131
    ds_read2_b32 v[124:125], v14 offset0:160 offset1:161
    s_waitcnt lgkmcnt(11)
    ds_read2_b32 v[126:127], v14 offset0:162 offset1:163
    ds_read2_b32 v[128:129], v14 offset0:192 offset1:193
    ds_read2_b32 v[130:131], v14 offset0:194 offset1:195
    ds_read2_b32 v[132:133], v14 offset0:224 offset1:225
    s_waitcnt lgkmcnt(11)
    ds_read2_b32 v[134:135], v14 offset0:226 offset1:227
    ds_read2_b32 v[136:137], v15 offset0:0 offset1:1
    ds_read2_b32 v[138:139], v15 offset0:2 offset1:3
    ds_read2_b32 v[140:141], v15 offset0:32 offset1:33
    s_waitcnt lgkmcnt(11)
    ds_read2_b32 v[142:143], v15 offset0:34 offset1:35
    ds_read2_b32 v[144:145], v15 offset0:64 offset1:65
    ds_read2_b32 v[146:147], v15 offset0:66 offset1:67
    ds_read2_b32 v[148:149], v15 offset0:96 offset1:97
    s_waitcnt lgkmcnt(11)
    ds_read2_b32 v[150:151], v15 offset0:98 offset1:99
    ds_read2_b32 v[152:153], v15 offset0:128 offset1:129
    ds_read2_b32 v[154:155], v15 offset0:130 offset1:131
    ds_read2_b32 v[156:157], v15 offset0:160 offset1:161
    s_waitcnt lgkmcnt(11)
    ds_read2_b32 v[158:159], v15 offset0:162 offset1:163
    ds_read2_b32 v[160:161], v15 offset0:192 offset1:193
    ds_read2_b32 v[162:163], v15 offset0:194 offset1:195
    ds_read2_b32 v[164:165], v15 offset0:224 offset1:225
    s_waitcnt lgkmcnt(11)
    ds_read2_b32 v[166:167], v15 offset0:226 offset1:227
    ds_read2_b32 v[168:169], v16 offset0:0 offset1:1
    ds_read2_b32 v[170:171], v16 offset0:2 offset1:3
    ds_read2_b32 v[172:173], v16 offset0:32 offset1:33
    s_waitcnt lgkmcnt(11)
    ds_read2_b32 v[174:175], v16 offset0:34 offset1:35
    ds_read2_b32 v[176:177], v16 offset0:64 offset1:65
    ds_read2_b32 v[178:179], v16 offset0:66 offset1:67
    ds_read2_b32 v[180:181], v16 offset0:96 offset1:97
    s_waitcnt lgkmcnt(11)
    ds_read2_b32 v[182:183], v16 offset0:98 offset1:99
    ds_read2_b32 v[184:185], v16 offset0:128 offset1:129
    ds_read2_b32 v[186:187], v16 offset0:130 offset1:131
    ds_read2_b32 v[188:189], v16 offset0:160 offset1:161
    s_waitcnt lgkmcnt(11)
    ds_read2_b32 v[190:191], v16 offset0:162 offset1:163
    ds_read2_b32 v[192:193], v16 offset0:192 offset1:193
    ds_read2_b32 v[194:195], v16 offset0:194 offset1:195
    ds_read2_b32 v[196:197], v16 offset0:224 offset1:225
    s_waitcnt lgkmcnt(11)
    ds_read2_b32 v[198:199], v16 offset0:226 offset1:227
    s_lshl_b32 s3, s36, 12
    s_add_u32 s3, s3, 131328
    v_bfe_u32 v21, v3, 1, 2
    v_xor_b32 v21, v21, v4
    v_lshl_add_u32 v21, v3, 2, v21
    v_lshl_add_u32 v21, v21, 4, s3
    v_subrev_u32 v22, 16640, v21
    s_waitcnt lgkmcnt(0)
    s_barrier
    s_setprio 3
    ds_read_b128 v[24:27], v12 offset:3968
    ds_read_b128 v[28:31], v12 offset:3840
    ds_read_b128 v[32:35], v12 offset:3712
    ds_read_b128 v[36:39], v12 offset:3584
    ds_read_b128 v[200:203], v12 offset:3456
    ds_read_b128 v[204:207], v12 offset:3328
    ds_read_b128 v[208:211], v12 offset:3200
    ds_read_b128 v[212:215], v12 offset:3072
    ds_read_b128 v[216:219], v12 offset:2944
    ds_read_b128 v[220:223], v12 offset:2816
    ds_read_b128 v[224:227], v12 offset:2688
    ds_read_b128 v[228:231], v12 offset:2560
    s_waitcnt lgkmcnt(11)
    v_mfma_f32_16x16x32_bf16 v[40:43], v[84:87], v[24:27], 0
    ds_read_b128 v[232:235], v12 offset:2432
    v_mfma_f32_16x16x32_bf16 v[44:47], v[100:103], v[24:27], 0
    v_mfma_f32_16x16x32_bf16 v[48:51], v[116:119], v[24:27], 0
    v_mfma_f32_16x16x32_bf16 v[52:55], v[132:135], v[24:27], 0
    s_waitcnt lgkmcnt(11)
    v_mfma_f32_16x16x32_bf16 v[40:43], v[80:83], v[28:31], v[40:43]
    ds_read_b128 v[236:239], v12 offset:2304
    v_mfma_f32_16x16x32_bf16 v[44:47], v[96:99], v[28:31], v[44:47]
    v_mfma_f32_16x16x32_bf16 v[48:51], v[112:115], v[28:31], v[48:51]
    v_mfma_f32_16x16x32_bf16 v[52:55], v[128:131], v[28:31], v[52:55]
    s_waitcnt lgkmcnt(11)
    v_mfma_f32_16x16x32_bf16 v[40:43], v[76:79], v[32:35], v[40:43]
    ds_read_b128 v[240:243], v12 offset:2176
    v_mfma_f32_16x16x32_bf16 v[44:47], v[92:95], v[32:35], v[44:47]
    v_mfma_f32_16x16x32_bf16 v[48:51], v[108:111], v[32:35], v[48:51]
    v_mfma_f32_16x16x32_bf16 v[52:55], v[124:127], v[32:35], v[52:55]
    s_waitcnt lgkmcnt(11)
    v_mfma_f32_16x16x32_bf16 v[40:43], v[72:75], v[36:39], v[40:43]
    ds_read_b128 v[244:247], v12 offset:2048
    v_mfma_f32_16x16x32_bf16 v[44:47], v[88:91], v[36:39], v[44:47]
    v_mfma_f32_16x16x32_bf16 v[48:51], v[104:107], v[36:39], v[48:51]
    v_mfma_f32_16x16x32_bf16 v[52:55], v[120:123], v[36:39], v[52:55]
    s_waitcnt lgkmcnt(11)
    v_mfma_f32_16x16x32_bf16 v[44:47], v[84:87], v[200:203], v[44:47]
    ds_read_b128 v[248:251], v12 offset:1920
    v_mfma_f32_16x16x32_bf16 v[48:51], v[100:103], v[200:203], v[48:51]
    v_mfma_f32_16x16x32_bf16 v[52:55], v[116:119], v[200:203], v[52:55]
    s_waitcnt lgkmcnt(11)
    v_mfma_f32_16x16x32_bf16 v[44:47], v[80:83], v[204:207], v[44:47]
    ds_read_b128 v[252:255], v12 offset:1792
    v_mfma_f32_16x16x32_bf16 v[48:51], v[96:99], v[204:207], v[48:51]
    v_mfma_f32_16x16x32_bf16 v[52:55], v[112:115], v[204:207], v[52:55]
    s_waitcnt lgkmcnt(11)
    v_mfma_f32_16x16x32_bf16 v[44:47], v[76:79], v[208:211], v[44:47]
    v_mfma_f32_16x16x32_bf16 v[48:51], v[92:95], v[208:211], v[48:51]
    v_mfma_f32_16x16x32_bf16 v[52:55], v[108:111], v[208:211], v[52:55]
    ds_write_b128 v21, v[40:43] offset:0
    s_waitcnt lgkmcnt(11)
    v_mfma_f32_16x16x32_bf16 v[44:47], v[72:75], v[212:215], v[44:47]
    v_mfma_f32_16x16x32_bf16 v[48:51], v[88:91], v[212:215], v[48:51]
    v_mfma_f32_16x16x32_bf16 v[52:55], v[104:107], v[212:215], v[52:55]
    s_waitcnt lgkmcnt(10)
    v_mfma_f32_16x16x32_bf16 v[48:51], v[84:87], v[216:219], v[48:51]
    v_mfma_f32_16x16x32_bf16 v[52:55], v[100:103], v[216:219], v[52:55]
    s_waitcnt lgkmcnt(9)
    v_mfma_f32_16x16x32_bf16 v[48:51], v[80:83], v[220:223], v[48:51]
    v_mfma_f32_16x16x32_bf16 v[52:55], v[96:99], v[220:223], v[52:55]
    s_waitcnt lgkmcnt(8)
    v_mfma_f32_16x16x32_bf16 v[48:51], v[76:79], v[224:227], v[48:51]
    v_mfma_f32_16x16x32_bf16 v[52:55], v[92:95], v[224:227], v[52:55]
    ds_write_b128 v21, v[44:47] offset:1024
    s_waitcnt lgkmcnt(8)
    v_mfma_f32_16x16x32_bf16 v[48:51], v[72:75], v[228:231], v[48:51]
    v_mfma_f32_16x16x32_bf16 v[52:55], v[88:91], v[228:231], v[52:55]
    s_waitcnt lgkmcnt(7)
    v_mfma_f32_16x16x32_bf16 v[52:55], v[84:87], v[232:235], v[52:55]
    s_waitcnt lgkmcnt(6)
    v_mfma_f32_16x16x32_bf16 v[52:55], v[80:83], v[236:239], v[52:55]
    s_waitcnt lgkmcnt(5)
    v_mfma_f32_16x16x32_bf16 v[52:55], v[76:79], v[240:243], v[52:55]
    s_waitcnt lgkmcnt(4)
    v_mfma_f32_16x16x32_bf16 v[52:55], v[72:75], v[244:247], v[52:55]
    ds_write_b128 v21, v[48:51] offset:2048
    v_mfma_f32_16x16x32_bf16 v[56:59], v[148:151], v[24:27], 0
    v_mfma_f32_16x16x32_bf16 v[60:63], v[164:167], v[24:27], 0
    v_mfma_f32_16x16x32_bf16 v[64:67], v[180:183], v[24:27], 0
    v_mfma_f32_16x16x32_bf16 v[68:71], v[196:199], v[24:27], 0
    s_nop 2
    ds_write_b128 v21, v[52:55] offset:3072
    ds_read_b128 v[196:199], v12 offset:1664
    v_mfma_f32_16x16x32_bf16 v[56:59], v[144:147], v[28:31], v[56:59]
    ds_read_b128 v[24:27], v12 offset:1536
    v_mfma_f32_16x16x32_bf16 v[60:63], v[160:163], v[28:31], v[60:63]
    v_mfma_f32_16x16x32_bf16 v[64:67], v[176:179], v[28:31], v[64:67]
    s_waitcnt lgkmcnt(2)
    s_barrier
    v_mfma_f32_16x16x32_bf16 v[68:71], v[192:195], v[28:31], v[68:71]
    ds_read_b128 v[192:195], v12 offset:1408
    v_mfma_f32_16x16x32_bf16 v[56:59], v[140:143], v[32:35], v[56:59]
    ds_read_b128 v[28:31], v12 offset:1280
    v_mfma_f32_16x16x32_bf16 v[60:63], v[156:159], v[32:35], v[60:63]
    v_mfma_f32_16x16x32_bf16 v[64:67], v[172:175], v[32:35], v[64:67]
    v_mfma_f32_16x16x32_bf16 v[68:71], v[188:191], v[32:35], v[68:71]
    ds_read_b128 v[188:191], v12 offset:1152
    v_mfma_f32_16x16x32_bf16 v[56:59], v[136:139], v[36:39], v[56:59]
    ds_read_b128 v[32:35], v12 offset:1024
    v_mfma_f32_16x16x32_bf16 v[60:63], v[152:155], v[36:39], v[60:63]
    v_mfma_f32_16x16x32_bf16 v[64:67], v[168:171], v[36:39], v[64:67]
    v_mfma_f32_16x16x32_bf16 v[68:71], v[184:187], v[36:39], v[68:71]
    ds_read_b128 v[184:187], v12 offset:896
    v_mfma_f32_16x16x32_bf16 v[56:59], v[132:135], v[200:203], v[56:59]
    ds_read_b128 v[36:39], v12 offset:768
    v_mfma_f32_16x16x32_bf16 v[60:63], v[148:151], v[200:203], v[60:63]
    v_mfma_f32_16x16x32_bf16 v[64:67], v[164:167], v[200:203], v[64:67]
    v_mfma_f32_16x16x32_bf16 v[68:71], v[180:183], v[200:203], v[68:71]
    ds_read_b128 v[180:183], v12 offset:640
    v_mfma_f32_16x16x32_bf16 v[56:59], v[128:131], v[204:207], v[56:59]
    ds_read_b128 v[200:203], v12 offset:512
    v_mfma_f32_16x16x32_bf16 v[60:63], v[144:147], v[204:207], v[60:63]
    v_mfma_f32_16x16x32_bf16 v[64:67], v[160:163], v[204:207], v[64:67]
    v_mfma_f32_16x16x32_bf16 v[68:71], v[176:179], v[204:207], v[68:71]
    ds_read_b128 v[176:179], v12 offset:384
    v_mfma_f32_16x16x32_bf16 v[56:59], v[124:127], v[208:211], v[56:59]
    ds_read_b128 v[204:207], v12 offset:256
    v_mfma_f32_16x16x32_bf16 v[60:63], v[140:143], v[208:211], v[60:63]
    v_mfma_f32_16x16x32_bf16 v[64:67], v[156:159], v[208:211], v[64:67]
    v_mfma_f32_16x16x32_bf16 v[68:71], v[172:175], v[208:211], v[68:71]
    v_mfma_f32_16x16x32_bf16 v[56:59], v[120:123], v[212:215], v[56:59]
    v_mfma_f32_16x16x32_bf16 v[60:63], v[136:139], v[212:215], v[60:63]
    v_mfma_f32_16x16x32_bf16 v[64:67], v[152:155], v[212:215], v[64:67]
    v_mfma_f32_16x16x32_bf16 v[68:71], v[168:171], v[212:215], v[68:71]
    v_mfma_f32_16x16x32_bf16 v[56:59], v[116:119], v[216:219], v[56:59]
    v_mfma_f32_16x16x32_bf16 v[60:63], v[132:135], v[216:219], v[60:63]
    v_mfma_f32_16x16x32_bf16 v[64:67], v[148:151], v[216:219], v[64:67]
    v_mfma_f32_16x16x32_bf16 v[68:71], v[164:167], v[216:219], v[68:71]
    v_mfma_f32_16x16x32_bf16 v[56:59], v[112:115], v[220:223], v[56:59]
    v_mfma_f32_16x16x32_bf16 v[60:63], v[128:131], v[220:223], v[60:63]
    v_mfma_f32_16x16x32_bf16 v[64:67], v[144:147], v[220:223], v[64:67]
    v_mfma_f32_16x16x32_bf16 v[68:71], v[160:163], v[220:223], v[68:71]
    v_mfma_f32_16x16x32_bf16 v[56:59], v[108:111], v[224:227], v[56:59]
    v_mfma_f32_16x16x32_bf16 v[60:63], v[124:127], v[224:227], v[60:63]
    v_mfma_f32_16x16x32_bf16 v[64:67], v[140:143], v[224:227], v[64:67]
    v_mfma_f32_16x16x32_bf16 v[68:71], v[156:159], v[224:227], v[68:71]
    v_mfma_f32_16x16x32_bf16 v[56:59], v[104:107], v[228:231], v[56:59]
    v_mfma_f32_16x16x32_bf16 v[60:63], v[120:123], v[228:231], v[60:63]
    v_mfma_f32_16x16x32_bf16 v[64:67], v[136:139], v[228:231], v[64:67]
    v_mfma_f32_16x16x32_bf16 v[68:71], v[152:155], v[228:231], v[68:71]
    v_mfma_f32_16x16x32_bf16 v[56:59], v[100:103], v[232:235], v[56:59]
    v_mfma_f32_16x16x32_bf16 v[60:63], v[116:119], v[232:235], v[60:63]
    v_mfma_f32_16x16x32_bf16 v[64:67], v[132:135], v[232:235], v[64:67]
    v_mfma_f32_16x16x32_bf16 v[68:71], v[148:151], v[232:235], v[68:71]
    v_mfma_f32_16x16x32_bf16 v[56:59], v[96:99], v[236:239], v[56:59]
    v_mfma_f32_16x16x32_bf16 v[60:63], v[112:115], v[236:239], v[60:63]
    v_mfma_f32_16x16x32_bf16 v[64:67], v[128:131], v[236:239], v[64:67]
    v_mfma_f32_16x16x32_bf16 v[68:71], v[144:147], v[236:239], v[68:71]
    v_mfma_f32_16x16x32_bf16 v[56:59], v[92:95], v[240:243], v[56:59]
    v_mfma_f32_16x16x32_bf16 v[60:63], v[108:111], v[240:243], v[60:63]
    v_mfma_f32_16x16x32_bf16 v[64:67], v[124:127], v[240:243], v[64:67]
    v_mfma_f32_16x16x32_bf16 v[68:71], v[140:143], v[240:243], v[68:71]
    v_mfma_f32_16x16x32_bf16 v[56:59], v[88:91], v[244:247], v[56:59]
    v_mfma_f32_16x16x32_bf16 v[60:63], v[104:107], v[244:247], v[60:63]
    v_mfma_f32_16x16x32_bf16 v[64:67], v[120:123], v[244:247], v[64:67]
    v_mfma_f32_16x16x32_bf16 v[68:71], v[136:139], v[244:247], v[68:71]
    v_mfma_f32_16x16x32_bf16 v[56:59], v[84:87], v[248:251], v[56:59]
    v_mfma_f32_16x16x32_bf16 v[60:63], v[100:103], v[248:251], v[60:63]
    v_mfma_f32_16x16x32_bf16 v[64:67], v[116:119], v[248:251], v[64:67]
    v_mfma_f32_16x16x32_bf16 v[68:71], v[132:135], v[248:251], v[68:71]
    v_mfma_f32_16x16x32_bf16 v[56:59], v[80:83], v[252:255], v[56:59]
    v_mfma_f32_16x16x32_bf16 v[60:63], v[96:99], v[252:255], v[60:63]
    v_mfma_f32_16x16x32_bf16 v[64:67], v[112:115], v[252:255], v[64:67]
    v_mfma_f32_16x16x32_bf16 v[68:71], v[128:131], v[252:255], v[68:71]
    s_waitcnt lgkmcnt(11)
    v_mfma_f32_16x16x32_bf16 v[56:59], v[76:79], v[196:199], v[56:59]
    ds_read_b128 v[172:175], v12 offset:128
    v_mfma_f32_16x16x32_bf16 v[60:63], v[92:95], v[196:199], v[60:63]
    v_mfma_f32_16x16x32_bf16 v[64:67], v[108:111], v[196:199], v[64:67]
    v_mfma_f32_16x16x32_bf16 v[68:71], v[124:127], v[196:199], v[68:71]
    s_waitcnt lgkmcnt(11)
    v_mfma_f32_16x16x32_bf16 v[56:59], v[72:75], v[24:27], v[56:59]
    ds_read_b128 v[208:211], v12 offset:0
    v_mfma_f32_16x16x32_bf16 v[60:63], v[88:91], v[24:27], v[60:63]
    v_mfma_f32_16x16x32_bf16 v[64:67], v[104:107], v[24:27], v[64:67]
    v_mfma_f32_16x16x32_bf16 v[68:71], v[120:123], v[24:27], v[68:71]
    s_waitcnt lgkmcnt(11)
    v_mfma_f32_16x16x32_bf16 v[60:63], v[84:87], v[192:195], v[60:63]
    v_mfma_f32_16x16x32_bf16 v[64:67], v[100:103], v[192:195], v[64:67]
    v_mfma_f32_16x16x32_bf16 v[68:71], v[116:119], v[192:195], v[68:71]
    s_waitcnt lgkmcnt(10)
    v_mfma_f32_16x16x32_bf16 v[60:63], v[80:83], v[28:31], v[60:63]
    v_mfma_f32_16x16x32_bf16 v[64:67], v[96:99], v[28:31], v[64:67]
    v_mfma_f32_16x16x32_bf16 v[68:71], v[112:115], v[28:31], v[68:71]
    s_waitcnt lgkmcnt(9)
    v_mfma_f32_16x16x32_bf16 v[60:63], v[76:79], v[188:191], v[60:63]
    v_mfma_f32_16x16x32_bf16 v[64:67], v[92:95], v[188:191], v[64:67]
    v_mfma_f32_16x16x32_bf16 v[68:71], v[108:111], v[188:191], v[68:71]
    s_waitcnt lgkmcnt(8)
    v_mfma_f32_16x16x32_bf16 v[60:63], v[72:75], v[32:35], v[60:63]
    v_mfma_f32_16x16x32_bf16 v[64:67], v[88:91], v[32:35], v[64:67]
    v_mfma_f32_16x16x32_bf16 v[68:71], v[104:107], v[32:35], v[68:71]
    s_waitcnt lgkmcnt(7)
    v_mfma_f32_16x16x32_bf16 v[64:67], v[84:87], v[184:187], v[64:67]
    v_mfma_f32_16x16x32_bf16 v[68:71], v[100:103], v[184:187], v[68:71]
    s_waitcnt lgkmcnt(6)
    v_mfma_f32_16x16x32_bf16 v[64:67], v[80:83], v[36:39], v[64:67]
    v_mfma_f32_16x16x32_bf16 v[68:71], v[96:99], v[36:39], v[68:71]
    s_waitcnt lgkmcnt(5)
    v_mfma_f32_16x16x32_bf16 v[64:67], v[76:79], v[180:183], v[64:67]
    v_mfma_f32_16x16x32_bf16 v[68:71], v[92:95], v[180:183], v[68:71]
    s_waitcnt lgkmcnt(4)
    v_mfma_f32_16x16x32_bf16 v[64:67], v[72:75], v[200:203], v[64:67]
    v_mfma_f32_16x16x32_bf16 v[68:71], v[88:91], v[200:203], v[68:71]
    s_waitcnt lgkmcnt(3)
    v_mfma_f32_16x16x32_bf16 v[68:71], v[84:87], v[176:179], v[68:71]
    s_waitcnt lgkmcnt(2)
    v_mfma_f32_16x16x32_bf16 v[68:71], v[80:83], v[204:207], v[68:71]
    s_waitcnt lgkmcnt(1)
    v_mfma_f32_16x16x32_bf16 v[68:71], v[76:79], v[172:175], v[68:71]
    s_waitcnt lgkmcnt(0)
    v_mfma_f32_16x16x32_bf16 v[68:71], v[72:75], v[208:211], v[68:71]
    ds_write_b128 v22, v[56:59] offset:0
    ds_write_b128 v22, v[60:63] offset:1024
    ds_write_b128 v22, v[64:67] offset:2048
    s_nop 4
    ds_write_b128 v22, v[68:71] offset:3072
    s_waitcnt lgkmcnt(0)
    s_setprio 0
    s_barrier
    s_branch Lf_join
La_ch:
    s_and_b32 s15, s36, 3
    s_lshl_b32 s3, s15, 10
    v_add_u32 v20, s3, v19
    v_add_u32 v7, 4096, v20
    v_lshrrev_b32 v8, 1, v20
    v_add_u32 v9, s3, v20
    s_mul_i32 s12, s62, 12288
    s_add_u32 s12, s12, 0xf00000
    s_add_u32 s13, s12, 8192
    s_add_u32 s14, s12, 16384
    s_lshl_b32 s58, s62, 12
    s_add_u32 s58, s58, 0x380000
    s_add_u32 s57, s58, 4096
    s_mov_b32 s56, 0xc40000
    s_mov_b32 s61, 0xc42000
    v_sub_u32 v18, 149752, v8
    v_bfe_u32 v21, v1, 3, 2
    v_lshlrev_b32 v21, 4, v21
    v_xor_b32 v21, v21, v20
    v_add_u32 v22, 114688, v21
    v_add_u32 v21, 131328, v21
    s_lshl_b32 s34, s15, 8
    s_lshr_b32 s3, s62, 1
    s_add_u32 s34, s34, s3
    s_lshl_b32 s34, s34, 7
    s_add_u32 s34, s34, 0xcd0000
    v_mov_b32 v16, s63
    s_waitcnt vmcnt(0)
    buffer_load_dwordx4 v[136:139], v20, s[16:19], s12 offen sc1
    buffer_load_dwordx4 v[140:143], v20, s[16:19], s13 offen sc1
    buffer_load_dwordx4 v[144:147], v20, s[16:19], s14 offen sc1
    buffer_load_dwordx4 v[148:151], v7, s[16:19], s12 offen sc1
    buffer_load_dwordx4 v[152:155], v7, s[16:19], s13 offen sc1
    buffer_load_dwordx4 v[156:159], v7, s[16:19], s14 offen sc1
    s_mov_b32 s59, 0
    s_waitcnt vmcnt(0)
La_k2:
    v_xor_b32 v40, s63, v139
    v_xor_b32 v41, s63, v143
    v_xor_b32 v42, s63, v147
    v_xor_b32 v43, s63, v151
    v_xor_b32 v44, s63, v155
    v_xor_b32 v45, s63, v159
    v_or3_b32 v40, v40, v41, v42
    v_or3_b32 v43, v43, v44, v45
    v_or_b32 v40, v40, v43
    v_cmp_ne_u32 vcc, 0, v40
    s_cmp_gt_u32 s59, 262144
    s_cbranch_scc1 La_k2go
    s_cbranch_vccz La_k2go
    s_mov_b64 exec, vcc
    buffer_load_dwordx4 v[136:139], v20, s[16:19], s12 offen sc1
    buffer_load_dwordx4 v[140:143], v20, s[16:19], s13 offen sc1
    buffer_load_dwordx4 v[144:147], v20, s[16:19], s14 offen sc1
    buffer_load_dwordx4 v[148:151], v7, s[16:19], s12 offen sc1
    buffer_load_dwordx4 v[152:155], v7, s[16:19], s13 offen sc1
    buffer_load_dwordx4 v[156:159], v7, s[16:19], s14 offen sc1
    s_add_u32 s59, s59, 1
    s_waitcnt vmcnt(0)
    s_branch La_k2
La_k2go:
    s_mov_b64 exec, -1
    ds_write_b64 v18, v[136:137] offset:2048
    ds_write_b64 v18, v[140:141] offset:6656
    ds_write_b64 v18, v[148:149] offset:0
    ds_write_b64 v18, v[152:153] offset:4608
    buffer_load_dwordx4 v[104:107], v9, s[16:19], s56 offen offset:0 sc1
    buffer_load_dwordx4 v[108:111], v9, s[16:19], s56 offen offset:1024 sc1
    buffer_load_dwordx4 v[112:115], v9, s[16:19], s61 offen offset:0 sc1
    buffer_load_dwordx4 v[116:119], v9, s[16:19], s61 offen offset:1024 sc1
    s_waitcnt lgkmcnt(0)
    s_barrier
    s_sub_u32 s8, s8, 114688
    s_sub_u32 s9, s9, 8192
    s_mov_b32 s20, s44
    s_mov_b32 s21, s45
    s_mov_b32 s22, 0x188000
    s_mov_b32 s23, 0x20000
    v_min_u32 v10, 13, v1
    v_lshlrev_b32 v10, 7, v10
    s_lshl_b32 s3, s37, 2
    s_add_u32 s3, s3, s15
    s_mul_i32 s3, s3, 1792
    buffer_load_dword v10, v10, s[20:23], s3 offen
    s_add_u32 m0, s9, 16384
    s_nop 0
    buffer_load_dwordx4 v2, s[24:27], s8 offen lds
    s_add_u32 m0, s9, 20480
    s_nop 0
    buffer_load_dwordx4 v5, s[28:31], s8 offen lds
    s_add_u32 s8, s8, 114688
    s_add_u32 m0, s9, 24576
    s_nop 0
    buffer_load_dwordx4 v2, s[24:27], s8 offen lds
    s_add_u32 m0, s9, 28672
    s_nop 0
    buffer_load_dwordx4 v5, s[28:31], s8 offen lds
    s_add_u32 s8, s8, 114688
    s_add_u32 m0, s9, 32768
    s_nop 0
    buffer_load_dwordx4 v2, s[24:27], s8 offen lds
    s_add_u32 m0, s9, 36864
    s_nop 0
    buffer_load_dwordx4 v5, s[28:31], s8 offen lds
    s_add_u32 s8, s8, 114688
    s_mov_b32 s59, 0
    s_waitcnt vmcnt(7)
La_sc:
    v_xor_b32 v40, s63, v105
    v_xor_b32 v41, s63, v107
    v_xor_b32 v42, s63, v109
    v_xor_b32 v43, s63, v111
    v_xor_b32 v44, s63, v113
    v_xor_b32 v45, s63, v115
    v_xor_b32 v46, s63, v117
    v_xor_b32 v47, s63, v119
    v_or3_b32 v40, v40, v41, v42
    v_or3_b32 v43, v43, v44, v45
    v_or3_b32 v40, v40, v46, v47
    v_or_b32 v40, v40, v43
    v_cmp_ne_u32 vcc, 0, v40
    s_cmp_gt_u32 s59, 262144
    s_cbranch_scc1 La_sgo
    s_cbranch_vccz La_sgo
    s_add_u32 s59, s59, 1
    buffer_load_dwordx4 v[104:107], v9, s[16:19], s56 offen offset:0 sc1
    buffer_load_dwordx4 v[108:111], v9, s[16:19], s56 offen offset:1024 sc1
    buffer_load_dwordx4 v[112:115], v9, s[16:19], s61 offen offset:0 sc1
    buffer_load_dwordx4 v[116:119], v9, s[16:19], s61 offen offset:1024 sc1
    s_waitcnt vmcnt(0)
    s_branch La_sc
La_sgo:
    v_and_b32 v60, 0xffff0000, v104
    v_lshlrev_b32 v56, 16, v104
    v_rcp_f32 v60, v60
    v_and_b32 v61, 0xffff0000, v106
    v_lshlrev_b32 v57, 16, v106
    v_rcp_f32 v61, v61
    v_and_b32 v62, 0xffff0000, v108
    v_lshlrev_b32 v58, 16, v108
    v_rcp_f32 v62, v62
    v_and_b32 v63, 0xffff0000, v110
    v_lshlrev_b32 v59, 16, v110
    v_rcp_f32 v63, v63
    v_lshlrev_b32 v88, 16, v138
    v_and_b32 v89, 0xffff0000, v138
    v_lshlrev_b32 v90, 16, v142
    v_and_b32 v91, 0xffff0000, v142
    v_sub_f32 v40, v88, v56
    v_sub_f32 v41, v89, v57
    v_sub_f32 v42, v90, v58
    v_sub_f32 v43, v91, v59
    v_mul_f32 v40, v40, v60
    v_mul_f32 v41, v41, v61
    v_mul_f32 v42, v42, v62
    v_mul_f32 v43, v43, v63
    v_lshlrev_b32 v92, 16, v144
    v_and_b32 v93, 0xffff0000, v144
    v_lshlrev_b32 v94, 16, v145
    v_and_b32 v95, 0xffff0000, v145
    v_sub_f32 v44, v92, v56
    v_sub_f32 v45, v93, v57
    v_sub_f32 v46, v94, v58
    v_sub_f32 v47, v95, v59
    v_mul_f32 v44, v44, v60
    v_mul_f32 v45, v45, v61
    v_mul_f32 v46, v46, v62
    v_mul_f32 v47, v47, v63
    s_setprio 3
    s_barrier
    ds_read_b128 v[120:123], v21 offset:0
    ds_read_b128 v[124:127], v21 offset:4096
    ds_read_b128 v[128:131], v21 offset:8192
    ds_read_b128 v[132:135], v21 offset:12288
    s_waitcnt lgkmcnt(2)
    v_add_f32 v120, v120, v124
    v_add_f32 v121, v121, v125
    v_add_f32 v122, v122, v126
    v_add_f32 v123, v123, v127
    v_fmac_f32 v88, v40, v120
    v_fmac_f32 v89, v41, v121
    v_fmac_f32 v90, v42, v122
    v_fmac_f32 v91, v43, v123
    v_cvt_pk_bf16_f32 v24, v88, v89
    v_cvt_pk_bf16_f32 v25, v90, v91
    buffer_store_dwordx2 v[24:25], v8, s[16:19], s58 offen offset:0 sc1
    s_waitcnt lgkmcnt(0)
    v_add_f32 v128, v128, v132
    v_add_f32 v129, v129, v133
    v_add_f32 v130, v130, v134
    v_add_f32 v131, v131, v135
    v_fmac_f32 v92, v44, v128
    v_fmac_f32 v93, v45, v129
    v_fmac_f32 v94, v46, v130
    v_fmac_f32 v95, v47, v131
    v_cvt_pk_bf16_f32 v26, v92, v93
    v_cvt_pk_bf16_f32 v27, v94, v95
    buffer_store_dwordx2 v[26:27], v8, s[16:19], s57 offen offset:0 sc1
    s_setprio 0
    v_and_b32 v60, 0xffff0000, v112
    v_lshlrev_b32 v56, 16, v112
    v_rcp_f32 v60, v60
    v_and_b32 v61, 0xffff0000, v114
    v_lshlrev_b32 v57, 16, v114
    v_rcp_f32 v61, v61
    v_and_b32 v62, 0xffff0000, v116
    v_lshlrev_b32 v58, 16, v116
    v_rcp_f32 v62, v62
    v_and_b32 v63, 0xffff0000, v118
    v_lshlrev_b32 v59, 16, v118
    v_rcp_f32 v63, v63
    v_lshlrev_b32 v96, 16, v150
    v_and_b32 v97, 0xffff0000, v150
    v_lshlrev_b32 v98, 16, v154
    v_and_b32 v99, 0xffff0000, v154
    v_sub_f32 v48, v96, v56
    v_sub_f32 v49, v97, v57
    v_sub_f32 v50, v98, v58
    v_sub_f32 v51, v99, v59
    v_mul_f32 v48, v48, v60
    v_mul_f32 v49, v49, v61
    v_mul_f32 v50, v50, v62
    v_mul_f32 v51, v51, v63
    v_lshlrev_b32 v100, 16, v156
    v_and_b32 v101, 0xffff0000, v156
    v_lshlrev_b32 v102, 16, v157
    v_and_b32 v103, 0xffff0000, v157
    v_sub_f32 v52, v100, v56
    v_sub_f32 v53, v101, v57
    v_sub_f32 v54, v102, v58
    v_sub_f32 v55, v103, v59
    v_mul_f32 v52, v52, v60
    v_mul_f32 v53, v53, v61
    v_mul_f32 v54, v54, v62
    v_mul_f32 v55, v55, v63
    s_waitcnt vmcnt(0)
    s_mov_b64 exec, 1
    buffer_store_dword v16, v17, s[16:19], s34 offen sc1
    s_mov_b64 exec, -1
    s_add_u32 s34, s34, 131072
    s_add_u32 m0, s9, 40960
    s_nop 0
    buffer_load_dwordx4 v2, s[24:27], s8 offen lds
    s_add_u32 m0, s9, 45056
    s_nop 0
    buffer_load_dwordx4 v5, s[28:31], s8 offen lds
    s_add_u32 s8, s8, 114688
    s_add_u32 m0, s9, 49152
    s_nop 0
    buffer_load_dwordx4 v2, s[24:27], s8 offen lds
    s_add_u32 m0, s9, 53248
    s_nop 0
    buffer_load_dwordx4 v5, s[28:31], s8 offen lds
    s_add_u32 s8, s8, 114688
    s_add_u32 m0, s9, 57344
    s_nop 0
    buffer_load_dwordx4 v2, s[24:27], s8 offen lds
    s_add_u32 m0, s9, 61440
    s_nop 0
    buffer_load_dwordx4 v5, s[28:31], s8 offen lds
    s_add_u32 s8, s8, 114688
    s_add_u32 m0, s9, 65536
    s_nop 0
    buffer_load_dwordx4 v2, s[24:27], s8 offen lds
    s_add_u32 m0, s9, 69632
    s_nop 0
    buffer_load_dwordx4 v5, s[28:31], s8 offen lds
    s_add_u32 s8, s8, 114688
    s_add_u32 m0, s9, 73728
    s_nop 0
    buffer_load_dwordx4 v2, s[24:27], s8 offen lds
    s_add_u32 m0, s9, 77824
    s_nop 0
    buffer_load_dwordx4 v5, s[28:31], s8 offen lds
    s_add_u32 s8, s8, 114688
    s_add_u32 m0, s9, 81920
    s_nop 0
    buffer_load_dwordx4 v2, s[24:27], s8 offen lds
    s_add_u32 m0, s9, 86016
    s_nop 0
    buffer_load_dwordx4 v5, s[28:31], s8 offen lds
    s_add_u32 s8, s8, 114688
    s_add_u32 m0, s9, 90112
    s_nop 0
    buffer_load_dwordx4 v2, s[24:27], s8 offen lds
    s_add_u32 m0, s9, 94208
    s_nop 0
    buffer_load_dwordx4 v5, s[28:31], s8 offen lds
    s_add_u32 s8, s8, 114688
    s_add_u32 m0, s9, 98304
    s_nop 0
    buffer_load_dwordx4 v2, s[24:27], s8 offen lds
    s_add_u32 m0, s9, 102400
    s_nop 0
    buffer_load_dwordx4 v5, s[28:31], s8 offen lds
    s_add_u32 s8, s8, 114688
    s_add_u32 m0, s9, 106496
    s_nop 0
    buffer_load_dwordx4 v2, s[24:27], s8 offen lds
    s_add_u32 m0, s9, 110592
    s_nop 0
    buffer_load_dwordx4 v5, s[28:31], s8 offen lds
    s_add_u32 s8, s8, 114688
    s_waitcnt vmcnt(14)
    s_setprio 3
    s_barrier
    ds_read_b128 v[120:123], v22 offset:0
    ds_read_b128 v[124:127], v22 offset:4096
    ds_read_b128 v[128:131], v22 offset:8192
    ds_read_b128 v[132:135], v22 offset:12288
    s_waitcnt lgkmcnt(2)
    v_add_f32 v120, v120, v124
    v_add_f32 v121, v121, v125
    v_add_f32 v122, v122, v126
    v_add_f32 v123, v123, v127
    v_fmac_f32 v96, v48, v120
    v_fmac_f32 v97, v49, v121
    v_fmac_f32 v98, v50, v122
    v_fmac_f32 v99, v51, v123
    v_cvt_pk_bf16_f32 v28, v96, v97
    v_cvt_pk_bf16_f32 v29, v98, v99
    buffer_store_dwordx2 v[28:29], v8, s[16:19], s58 offen offset:2048 sc1
    s_waitcnt lgkmcnt(0)
    v_add_f32 v128, v128, v132
    v_add_f32 v129, v129, v133
    v_add_f32 v130, v130, v134
    v_add_f32 v131, v131, v135
    v_fmac_f32 v100, v52, v128
    v_fmac_f32 v101, v53, v129
    v_fmac_f32 v102, v54, v130
    v_fmac_f32 v103, v55, v131
    v_cvt_pk_bf16_f32 v30, v100, v101
    v_cvt_pk_bf16_f32 v31, v102, v103
    buffer_store_dwordx2 v[30:31], v8, s[16:19], s57 offen offset:2048 sc1
    s_setprio 0
Lf_join:
    ds_read_b64_tr_b16 v[200:201], v6 offset:0
    ds_read_b64_tr_b16 v[202:203], v6 offset:512
    ds_read_b64_tr_b16 v[204:205], v6 offset:2048
    ds_read_b64_tr_b16 v[206:207], v6 offset:2560
    ds_read_b64_tr_b16 v[208:209], v6 offset:8192
    ds_read_b64_tr_b16 v[210:211], v6 offset:8704
    ds_read_b64_tr_b16 v[212:213], v6 offset:10240
    ds_read_b64_tr_b16 v[214:215], v6 offset:10752
    ds_read_b64_tr_b16 v[216:217], v6 offset:16384
    ds_read_b64_tr_b16 v[218:219], v6 offset:16896
    ds_read_b64_tr_b16 v[220:221], v6 offset:18432
    ds_read_b64_tr_b16 v[222:223], v6 offset:18944
    ds_read_b64_tr_b16 v[224:225], v6 offset:24576
    ds_read_b64_tr_b16 v[226:227], v6 offset:25088
    ds_read_b64_tr_b16 v[228:229], v6 offset:26624
    s_waitcnt lgkmcnt(11)
    ds_read_b64_tr_b16 v[230:231], v6 offset:27136
    ds_read_b64_tr_b16 v[232:233], v6 offset:32768
    ds_read_b64_tr_b16 v[234:235], v6 offset:33280
    ds_read_b64_tr_b16 v[236:237], v6 offset:34816
    s_waitcnt lgkmcnt(11)
    ds_read_b64_tr_b16 v[238:239], v6 offset:35328
    ds_read_b64_tr_b16 v[240:241], v6 offset:40960
    ds_read_b64_tr_b16 v[242:243], v6 offset:41472
    ds_read_b64_tr_b16 v[244:245], v6 offset:43008
    s_waitcnt lgkmcnt(11)
    ds_read_b64_tr_b16 v[246:247], v6 offset:43520
    ds_read_b64_tr_b16 v[248:249], v6 offset:49152
    ds_read_b64_tr_b16 v[250:251], v6 offset:49664
    ds_read_b64_tr_b16 v[252:253], v6 offset:51200
    s_waitcnt lgkmcnt(11)
    ds_read_b64_tr_b16 v[254:255], v6 offset:51712
    v_add_u32 v23, 57344, v6
    s_lshr_b32 s57, s4, 1
    s_lshl_b32 s57, s57, 15
    s_add_u32 s57, s57, 0xcd0000
    v_min_u32 v18, 27, v1
    v_lshrrev_b32 v20, 2, v18
    v_and_b32 v18, 3, v18
    v_lshl_add_u32 v18, v20, 5, v18
    s_lshl_b32 s3, s36, 2
    v_add_lshl_u32 v18, s3, v18, 7
    v_lshrrev_b32 v3, 3, v1
    v_and_b32 v4, 7, v1
    v_mov_b32 v5, v18
    v_lshlrev_b32 v20, 1, v3
    v_and_b32 v20, 4, v20
    v_xor_b32 v20, v20, v4
    v_lshlrev_b32 v20, 4, v20
    v_lshl_add_u32 v2, v3, 12, v20
    v_mov_b32 v7, 896
    v_mad_u32_u24 v3, v3, v7, v20
    s_lshl_b32 s11, s36, 15
    s_lshl_b32 s3, s4, 8
    s_add_u32 s11, s11, s3
    s_add_u32 s11, s11, 0x380000
    v_lshrrev_b32 v8, 5, v1
    v_bfe_u32 v9, v1, 2, 2
    v_and_b32 v10, 3, v1
    v_bfe_u32 v11, v1, 4, 1
    v_lshrrev_b32 v12, 1, v9
    v_lshl_add_u32 v13, v8, 3, v9
    v_lshlrev_b32 v14, 5, v11
    v_lshl_add_u32 v14, v10, 3, v14
    v_lshl_add_u32 v14, v12, 6, v14
    v_lshl_add_u32 v6, v13, 7, v14
    s_lshl_b32 s3, s35, 6
    v_xor_b32 v6, s3, v6
    v_add_u32 v7, 57344, v6
    v_mov_b32 v4, 0
    v_mov_b32 v95, s63
    buffer_load_dword v22, v5, s[16:19], s57 offen sc1
    s_cmp_lt_u32 s36, 4
    s_waitcnt vmcnt(0)
    s_cbranch_scc1 Lf_nf
    s_mov_b64 exec, 1
    buffer_store_dword v95, v4, s[16:19], s34 offen sc1
    s_mov_b64 exec, -1
Lf_nf:
    v_cmp_ne_u32 vcc, s63, v22
    s_nop 1
    s_cbranch_vccz Lf_p2go
    s_mov_b32 s59, 0
Lf_p2:
    buffer_load_dword v22, v5, s[16:19], s57 offen sc1
    s_add_u32 s59, s59, 1
    s_waitcnt vmcnt(0)
    v_cmp_ne_u32 vcc, s63, v22
    s_cmp_gt_u32 s59, 262144
    s_cbranch_scc1 Lf_p2go
    s_cbranch_vccnz Lf_p2
Lf_p2go:
    s_add_u32 s57, s57, 131072
    s_waitcnt lgkmcnt(0)
    s_barrier
    s_add_u32 m0, s60, 0
    s_nop 0
    buffer_load_dwordx4 v2, s[16:19], s11 offen sc1 lds
    s_add_u32 m0, s60, 8192
    s_add_u32 s11, s11, 262144
    buffer_load_dwordx4 v2, s[16:19], s11 offen sc1 lds
    s_add_u32 m0, s60, 16384
    s_add_u32 s11, s11, 262144
    buffer_load_dwordx4 v2, s[16:19], s11 offen sc1 lds
    s_add_u32 m0, s60, 24576
    s_add_u32 s11, s11, 262144
    buffer_load_dwordx4 v2, s[16:19], s11 offen sc1 lds
    s_add_u32 m0, s60, 32768
    s_add_u32 s11, s11, 262144
    buffer_load_dwordx4 v2, s[16:19], s11 offen sc1 lds
    ds_read_b64_tr_b16 v[144:145], v23 offset:0
    ds_read_b64_tr_b16 v[146:147], v23 offset:512
    ds_read_b64_tr_b16 v[148:149], v23 offset:2048
    ds_read_b64_tr_b16 v[150:151], v23 offset:2560
    ds_read_b64_tr_b16 v[152:153], v23 offset:8192
    ds_read_b64_tr_b16 v[154:155], v23 offset:8704
    ds_read_b64_tr_b16 v[156:157], v23 offset:10240
    ds_read_b64_tr_b16 v[158:159], v23 offset:10752
    ds_read_b64_tr_b16 v[160:161], v23 offset:16384
    ds_read_b64_tr_b16 v[162:163], v23 offset:16896
    ds_read_b64_tr_b16 v[164:165], v23 offset:18432
    ds_read_b64_tr_b16 v[166:167], v23 offset:18944
    ds_read_b64_tr_b16 v[168:169], v23 offset:24576
    ds_read_b64_tr_b16 v[170:171], v23 offset:25088
    ds_read_b64_tr_b16 v[172:173], v23 offset:26624
    s_waitcnt lgkmcnt(11)
    ds_read_b64_tr_b16 v[174:175], v23 offset:27136
    ds_read_b64_tr_b16 v[176:177], v23 offset:32768
    ds_read_b64_tr_b16 v[178:179], v23 offset:33280
    ds_read_b64_tr_b16 v[180:181], v23 offset:34816
    s_waitcnt lgkmcnt(11)
    ds_read_b64_tr_b16 v[182:183], v23 offset:35328
    ds_read_b64_tr_b16 v[184:185], v23 offset:40960
    ds_read_b64_tr_b16 v[186:187], v23 offset:41472
    ds_read_b64_tr_b16 v[188:189], v23 offset:43008
    s_waitcnt lgkmcnt(11)
    ds_read_b64_tr_b16 v[190:191], v23 offset:43520
    ds_read_b64_tr_b16 v[192:193], v23 offset:49152
    ds_read_b64_tr_b16 v[194:195], v23 offset:49664
    ds_read_b64_tr_b16 v[196:197], v23 offset:51200
    s_waitcnt lgkmcnt(11)
    ds_read_b64_tr_b16 v[198:199], v23 offset:51712
    s_mov_b32 s20, s44
    s_mov_b32 s21, s45
    s_mov_b32 s22, 0x188000
    s_mov_b32 s23, 0x20000
    s_mov_b32 s52, s46
    s_mov_b32 s53, s47
    s_mov_b32 s54, 0x1c0000
    s_mov_b32 s55, 0x20000
    s_mul_i32 s8, s36, 200704
    s_lshl_b32 s3, s6, 7
    s_add_u32 s8, s8, s3
    s_mul_i32 s9, s36, 6144
    s_add_u32 s9, s9, 114688
    s_mul_i32 s10, s36, 7168
    s_and_b32 s12, s36, 1
    s_lshr_b32 s13, s36, 1
    s_lshl_b32 s14, s6, 6
    s_lshl_b32 s3, s12, 5
    s_add_u32 s14, s14, s3
    s_lshl_b32 s3, s13, 3
    s_add_u32 s14, s14, s3
    v_lshl_add_u32 v15, v8, 2, v9
    v_add_lshl_u32 v15, s14, v15, 7
    s_and_b32 s3, s7, 1
    s_lshl_b32 s3, s3, 6
    v_xor_b32 v14, s3, v14
    v_add_u32 v116, v15, v14
    v_xor_b32 v14, s12, v12
    v_lshlrev_b32 v14, 6, v14
    v_lshl_add_u32 v14, v13, 7, v14
    s_waitcnt lgkmcnt(0)
    s_waitcnt vmcnt(3)
    s_barrier
    ds_read_b64_tr_b16 v[48:49], v6 offset:0
    ds_read_b64_tr_b16 v[50:51], v6 offset:512
    ds_read_b64_tr_b16 v[52:53], v6 offset:2048
    ds_read_b64_tr_b16 v[54:55], v6 offset:2560
    ds_read_b64_tr_b16 v[56:57], v6 offset:4096
    ds_read_b64_tr_b16 v[58:59], v6 offset:4608
    ds_read_b64_tr_b16 v[60:61], v6 offset:6144
    ds_read_b64_tr_b16 v[62:63], v6 offset:6656
    s_waitcnt lgkmcnt(6)
    v_mfma_f32_32x32x16_bf16 v[16:31], v[200:203], v[48:51], 0
    ds_read_b64_tr_b16 v[64:65], v6 offset:8192
    ds_read_b64_tr_b16 v[66:67], v6 offset:8704
    v_lshrrev_b32 v15, 1, v10
    v_lshl_add_u32 v15, v11, 1, v15
    v_xor_b32 v15, s13, v15
    v_lshl_add_u32 v14, v15, 4, v14
    v_and_b32 v15, 1, v10
    s_add_u32 m0, s60, 40960
    s_add_u32 s11, s11, 262144
    buffer_load_dwordx4 v2, s[16:19], s11 offen sc1 lds
    s_waitcnt lgkmcnt(6)
    v_mfma_f32_32x32x16_bf16 v[16:31], v[204:207], v[52:55], v[16:31]
    ds_read_b64_tr_b16 v[48:49], v6 offset:10240
    ds_read_b64_tr_b16 v[50:51], v6 offset:10752
    v_lshl_add_u32 v14, v15, 3, v14
    v_add_u32 v12, s9, v14
    v_xor_b32 v13, 64, v12
    v_add_u32 v14, s10, v14
    v_xor_b32 v15, 64, v14
    s_add_u32 m0, s60, 49152
    s_add_u32 s11, s11, 262144
    buffer_load_dwordx4 v2, s[16:19], s11 offen sc1 lds
    s_waitcnt lgkmcnt(6)
    v_mfma_f32_32x32x16_bf16 v[16:31], v[208:211], v[56:59], v[16:31]
    ds_read_b64_tr_b16 v[52:53], v6 offset:12288
    ds_read_b64_tr_b16 v[54:55], v6 offset:12800
    v_and_b32 v9, 31, v1
    v_lshlrev_b32 v10, 3, v9
    s_lshl_b32 s24, s4, 2
    s_add_u32 s25, s24, s35
    s_lshl_b32 s48, s25, 8
    s_add_u32 m0, s60, 57344
    s_add_u32 s11, s11, 4293394560
    buffer_load_dwordx4 v2, s[16:19], s11 offen sc1 lds
    s_waitcnt lgkmcnt(6)
    v_mfma_f32_32x32x16_bf16 v[16:31], v[212:215], v[60:63], v[16:31]
    ds_read_b64_tr_b16 v[56:57], v6 offset:14336
    ds_read_b64_tr_b16 v[58:59], v6 offset:14848
    s_add_u32 s48, s48, 0xc4c000
    s_add_u32 s26, s48, 8192
    s_add_u32 s15, s24, s7
    s_lshl_b32 s3, s15, 5
    v_add_u32 v9, s3, v9
    s_add_u32 m0, s60, 65536
    s_add_u32 s11, s11, 262144
    buffer_load_dwordx4 v2, s[16:19], s11 offen sc1 lds
    s_waitcnt lgkmcnt(6)
    v_mfma_f32_32x32x16_bf16 v[16:31], v[216:219], v[64:67], v[16:31]
    s_waitcnt vmcnt(4)
    s_barrier
    ds_read_b64_tr_b16 v[60:61], v6 offset:16384
    ds_read_b64_tr_b16 v[62:63], v6 offset:16896
    v_mul_u32_u24 v9, 896, v9
    v_lshl_add_u32 v9, v8, 3, v9
    s_lshl_b32 s3, s14, 1
    v_add_u32 v117, s3, v9
    v_lshlrev_b32 v11, 4, v1
    s_waitcnt lgkmcnt(6)
    v_mfma_f32_32x32x16_bf16 v[16:31], v[220:223], v[48:51], v[16:31]
    ds_read_b64_tr_b16 v[64:65], v6 offset:18432
    ds_read_b64_tr_b16 v[66:67], v6 offset:18944
    s_lshl_b32 s51, s5, 2
    s_and_b32 s3, s36, 3
    s_add_u32 s51, s51, s3
    s_mul_i32 s49, s25, 112
    s_add_u32 s49, s49, s51
    s_add_u32 m0, s60, 73728
    s_add_u32 s11, s11, 262144
    buffer_load_dwordx4 v2, s[16:19], s11 offen sc1 lds
    s_waitcnt lgkmcnt(6)
    v_mfma_f32_32x32x16_bf16 v[16:31], v[224:227], v[52:55], v[16:31]
    ds_read_b64_tr_b16 v[48:49], v6 offset:20480
    ds_read_b64_tr_b16 v[50:51], v6 offset:20992
    s_lshl_b32 s51, s51, 8
    s_add_u32 s51, s51, 0xc54000
    s_lshl_b32 s50, s49, 7
    s_add_u32 s50, s50, 0xd20000
    s_lshl_b32 s49, s49, 10
    s_add_u32 m0, s60, 81920
    s_add_u32 s11, s11, 262144
    buffer_load_dwordx4 v2, s[16:19], s11 offen sc1 lds
    s_waitcnt lgkmcnt(6)
    v_mfma_f32_32x32x16_bf16 v[16:31], v[228:231], v[56:59], v[16:31]
    ds_read_b64_tr_b16 v[52:53], v6 offset:22528
    ds_read_b64_tr_b16 v[54:55], v6 offset:23040
    s_add_u32 s49, s49, 0x540000
    s_mul_i32 s32, s15, 112
    s_mul_i32 s3, s36, 14
    s_add_u32 s32, s32, s3
    s_lshl_b32 s33, s32, 7
    s_waitcnt lgkmcnt(6)
    v_mfma_f32_32x32x16_bf16 v[16:31], v[232:235], v[60:63], v[16:31]
    ds_read_b64_tr_b16 v[56:57], v6 offset:24576
    ds_read_b64_tr_b16 v[58:59], v6 offset:25088
    s_add_u32 s33, s33, 0xd20000
    s_lshl_b32 s32, s32, 10
    s_add_u32 s32, s32, 0x540000
    v_min_u32 v9, 13, v1
    v_lshlrev_b32 v9, 7, v9
    s_add_u32 m0, s60, 90112
    s_add_u32 s11, s11, 262144
    buffer_load_dwordx4 v2, s[16:19], s11 offen sc1 lds
    s_waitcnt lgkmcnt(6)
    v_mfma_f32_32x32x16_bf16 v[16:31], v[236:239], v[64:67], v[16:31]
    ds_read_b64_tr_b16 v[60:61], v6 offset:26624
    ds_read_b64_tr_b16 v[62:63], v6 offset:27136
    v_mov_b32 v106, 0
    v_mov_b32 v107, 0
    v_mov_b32 v109, 0
    v_mov_b32 v110, 0
    v_mov_b32 v111, 0
    s_add_u32 m0, s60, 98304
    s_add_u32 s11, s11, 262144
    buffer_load_dwordx4 v2, s[16:19], s11 offen sc1 lds
    s_waitcnt lgkmcnt(6)
    v_mfma_f32_32x32x16_bf16 v[16:31], v[240:243], v[48:51], v[16:31]
    ds_read_b64_tr_b16 v[64:65], v6 offset:28672
    ds_read_b64_tr_b16 v[66:67], v6 offset:29184
    s_cmp_lt_u32 s7, 2
    s_cselect_b64 s[28:29], 0, -1
    s_waitcnt lgkmcnt(6)
    v_mfma_f32_32x32x16_bf16 v[16:31], v[244:247], v[52:55], v[16:31]
    ds_read_b64_tr_b16 v[48:49], v6 offset:30720
    ds_read_b64_tr_b16 v[50:51], v6 offset:31232
    s_add_u32 m0, s60, 106496
    s_add_u32 s11, s11, 262144
    buffer_load_dwordx4 v2, s[16:19], s11 offen sc1 lds
    s_waitcnt lgkmcnt(6)
    v_mfma_f32_32x32x16_bf16 v[16:31], v[248:251], v[56:59], v[16:31]
    ds_read_b64_tr_b16 v[52:53], v6 offset:32768
    ds_read_b64_tr_b16 v[54:55], v6 offset:33280
    s_waitcnt lgkmcnt(6)
    v_mfma_f32_32x32x16_bf16 v[16:31], v[252:255], v[60:63], v[16:31]
    ds_read_b64_tr_b16 v[56:57], v6 offset:34816
    ds_read_b64_tr_b16 v[58:59], v6 offset:35328
    s_waitcnt lgkmcnt(6)
    v_mfma_f32_32x32x16_bf16 v[16:31], v[144:147], v[64:67], v[16:31]
    ds_read_b64_tr_b16 v[60:61], v6 offset:36864
    ds_read_b64_tr_b16 v[62:63], v6 offset:37376
    s_add_u32 m0, s9, 0
    s_nop 0
    buffer_load_dwordx4 v3, s[20:23], s8 offen lds
    s_waitcnt lgkmcnt(6)
    v_mfma_f32_32x32x16_bf16 v[16:31], v[148:151], v[48:51], v[16:31]
    ds_read_b64_tr_b16 v[64:65], v6 offset:38912
    ds_read_b64_tr_b16 v[66:67], v6 offset:39424
    s_add_u32 m0, s9, 1024
    s_add_u32 s8, s8, 7168
    buffer_load_dwordx4 v3, s[20:23], s8 offen lds
    s_waitcnt lgkmcnt(6)
    v_mfma_f32_32x32x16_bf16 v[16:31], v[152:155], v[52:55], v[16:31]
    s_waitcnt vmcnt(9)
    s_barrier
    ds_read_b64_tr_b16 v[48:49], v6 offset:40960
    ds_read_b64_tr_b16 v[50:51], v6 offset:41472
    s_waitcnt lgkmcnt(6)
    v_mfma_f32_32x32x16_bf16 v[16:31], v[156:159], v[56:59], v[16:31]
    ds_read_b64_tr_b16 v[52:53], v6 offset:43008
    ds_read_b64_tr_b16 v[54:55], v6 offset:43520
    s_waitcnt lgkmcnt(6)
    v_mfma_f32_32x32x16_bf16 v[16:31], v[160:163], v[60:63], v[16:31]
    ds_read_b64_tr_b16 v[56:57], v6 offset:45056
    ds_read_b64_tr_b16 v[58:59], v6 offset:45568
    s_add_u32 m0, s9, 2048
    s_add_u32 s8, s8, 7168
    buffer_load_dwordx4 v3, s[20:23], s8 offen lds
    s_waitcnt lgkmcnt(6)
    v_mfma_f32_32x32x16_bf16 v[16:31], v[164:167], v[64:67], v[16:31]
    ds_read_b64_tr_b16 v[60:61], v6 offset:47104
    ds_read_b64_tr_b16 v[62:63], v6 offset:47616
    s_add_u32 m0, s9, 3072
    s_add_u32 s8, s8, 7168
    buffer_load_dwordx4 v3, s[20:23], s8 offen lds
    s_waitcnt lgkmcnt(6)
    v_mfma_f32_32x32x16_bf16 v[16:31], v[168:171], v[48:51], v[16:31]
    ds_read_b64_tr_b16 v[64:65], v6 offset:49152
    ds_read_b64_tr_b16 v[66:67], v6 offset:49664
    ds_read_b64_tr_b16 v[112:113], v116
    s_waitcnt lgkmcnt(7)
    v_mfma_f32_32x32x16_bf16 v[16:31], v[172:175], v[52:55], v[16:31]
    ds_read_b64_tr_b16 v[48:49], v6 offset:51200
    ds_read_b64_tr_b16 v[50:51], v6 offset:51712
    s_add_u32 m0, s9, 4096
    s_add_u32 s8, s8, 7168
    buffer_load_dwordx4 v3, s[20:23], s8 offen lds
    s_waitcnt lgkmcnt(7)
    v_mfma_f32_32x32x16_bf16 v[16:31], v[176:179], v[56:59], v[16:31]
    ds_read_b64_tr_b16 v[52:53], v6 offset:53248
    ds_read_b64_tr_b16 v[54:55], v6 offset:53760
    s_add_u32 m0, s9, 5120
    s_add_u32 s8, s8, 7168
    buffer_load_dwordx4 v3, s[20:23], s8 offen lds
    s_waitcnt lgkmcnt(7)
    v_mfma_f32_32x32x16_bf16 v[16:31], v[180:183], v[60:63], v[16:31]
    ds_read_b64_tr_b16 v[56:57], v6 offset:55296
    ds_read_b64_tr_b16 v[58:59], v6 offset:55808
    buffer_load_dword v76, v5, s[16:19], s57 offen sc1
    s_waitcnt lgkmcnt(7)
    v_mfma_f32_32x32x16_bf16 v[16:31], v[184:187], v[64:67], v[16:31]
    s_waitcnt lgkmcnt(0)
    s_waitcnt vmcnt(7)
    s_barrier
    ds_read_b64_tr_b16 v[60:61], v7 offset:0
    ds_read_b64_tr_b16 v[62:63], v7 offset:512
    v_mfma_f32_32x32x16_bf16 v[16:31], v[188:191], v[48:51], v[16:31]
    ds_read_b64_tr_b16 v[64:65], v7 offset:2048
    ds_read_b64_tr_b16 v[66:67], v7 offset:2560
    buffer_load_dwordx2 v[104:105], v10, s[16:19], s51 offen sc1
    v_mfma_f32_32x32x16_bf16 v[16:31], v[192:195], v[52:55], v[16:31]
    ds_read_b64_tr_b16 v[48:49], v7 offset:4096
    ds_read_b64_tr_b16 v[50:51], v7 offset:4608
    buffer_load_dwordx2 v[96:97], v10, s[16:19], s48 offen offset:0 sc1
    v_mfma_f32_32x32x16_bf16 v[16:31], v[196:199], v[56:59], v[16:31]
    ds_read_b64_tr_b16 v[52:53], v7 offset:6144
    ds_read_b64_tr_b16 v[54:55], v7 offset:6656
    buffer_load_dwordx2 v[98:99], v10, s[16:19], s48 offen offset:512 sc1
    s_waitcnt lgkmcnt(6)
    v_mfma_f32_32x32x16_bf16 v[32:47], v[200:203], v[60:63], 0
    ds_read_b64_tr_b16 v[56:57], v7 offset:8192
    ds_read_b64_tr_b16 v[58:59], v7 offset:8704
    s_waitcnt vmcnt(8)
    ds_read_b64_tr_b16 v[120:121], v12 offset:0
    ds_read_b64_tr_b16 v[122:123], v12 offset:512
    s_waitcnt lgkmcnt(8)
    v_mfma_f32_32x32x16_bf16 v[32:47], v[204:207], v[64:67], v[32:47]
    ds_read_b64_tr_b16 v[60:61], v7 offset:10240
    ds_read_b64_tr_b16 v[62:63], v7 offset:10752
    ds_read_b64_tr_b16 v[124:125], v13 offset:0
    ds_read_b64_tr_b16 v[126:127], v13 offset:512
    s_waitcnt lgkmcnt(10)
    v_mfma_f32_32x32x16_bf16 v[32:47], v[208:211], v[48:51], v[32:47]
    ds_read_b64_tr_b16 v[64:65], v7 offset:12288
    ds_read_b64_tr_b16 v[66:67], v7 offset:12800
    s_waitcnt vmcnt(3)
    s_mov_b32 s59, 0
Lf_hlc:
    v_cmp_ne_u32 s[30:31], s63, v76
    s_cmp_gt_u32 s59, 262144
    s_cbranch_scc1 Lf_hlgo
    s_cmp_eq_u64 s[30:31], 0
    s_cbranch_scc1 Lf_hlgo
    buffer_load_dword v76, v5, s[16:19], s57 offen sc1
    s_add_u32 s59, s59, 1
    s_waitcnt vmcnt(0)
    s_branch Lf_hlc
Lf_hlgo:
    s_add_u32 m0, s60, 0
    s_add_u32 s11, s11, 4293396352
    buffer_load_dwordx4 v2, s[16:19], s11 offen sc1 lds
    ds_read_b64_tr_b16 v[128:129], v12 offset:2048
    ds_read_b64_tr_b16 v[130:131], v12 offset:2560
    s_waitcnt lgkmcnt(12)
    v_mfma_f32_32x32x16_bf16 v[32:47], v[212:215], v[52:55], v[32:47]
    ds_read_b64_tr_b16 v[48:49], v7 offset:14336
    ds_read_b64_tr_b16 v[50:51], v7 offset:14848
    s_add_u32 m0, s60, 8192
    s_add_u32 s11, s11, 262144
    buffer_load_dwordx4 v2, s[16:19], s11 offen sc1 lds
    ds_read_b64_tr_b16 v[132:133], v13 offset:2048
    s_waitcnt lgkmcnt(11)
    ds_read_b64_tr_b16 v[134:135], v13 offset:2560
    v_mfma_f32_32x32x16_bf16 v[32:47], v[216:219], v[56:59], v[32:47]
    ds_read_b64_tr_b16 v[52:53], v7 offset:16384
    ds_read_b64_tr_b16 v[54:55], v7 offset:16896
    ds_read_b64_tr_b16 v[136:137], v12 offset:4096
    s_waitcnt lgkmcnt(11)
    ds_read_b64_tr_b16 v[138:139], v12 offset:4608
    v_mfma_f32_32x32x16_bf16 v[32:47], v[220:223], v[60:63], v[32:47]
    ds_read_b64_tr_b16 v[56:57], v7 offset:18432
    ds_read_b64_tr_b16 v[58:59], v7 offset:18944
    ds_read_b64_tr_b16 v[118:119], v116 offset:57344
    s_add_u32 m0, s60, 16384
    s_add_u32 s11, s11, 262144
    buffer_load_dwordx4 v2, s[16:19], s11 offen sc1 lds
    s_waitcnt lgkmcnt(11)
    ds_read_b64_tr_b16 v[140:141], v13 offset:4096
    ds_read_b64_tr_b16 v[142:143], v13 offset:4608
    v_mfma_f32_32x32x16_bf16 v[32:47], v[224:227], v[64:67], v[32:47]
    ds_read_b64_tr_b16 v[60:61], v7 offset:20480
    ds_read_b64_tr_b16 v[62:63], v7 offset:20992
    s_add_u32 m0, s60, 24576
    s_add_u32 s11, s11, 262144
    buffer_load_dwordx4 v2, s[16:19], s11 offen sc1 lds
    s_waitcnt lgkmcnt(13)
    v_mfma_f32_32x32x16_bf16 v[32:47], v[228:231], v[48:51], v[32:47]
    ds_read_b64_tr_b16 v[64:65], v7 offset:22528
    ds_read_b64_tr_b16 v[66:67], v7 offset:23040
    s_waitcnt lgkmcnt(11)
    v_mfma_f32_32x32x16_bf16 v[32:47], v[232:235], v[52:55], v[32:47]
    ds_read_b64_tr_b16 v[48:49], v7 offset:24576
    ds_read_b64_tr_b16 v[50:51], v7 offset:25088
    s_add_u32 m0, s60, 32768
    s_add_u32 s11, s11, 262144
    buffer_load_dwordx4 v2, s[16:19], s11 offen sc1 lds
    s_waitcnt lgkmcnt(9)
    v_mfma_f32_32x32x16_bf16 v[32:47], v[236:239], v[56:59], v[32:47]
    ds_read_b64_tr_b16 v[52:53], v7 offset:26624
    ds_read_b64_tr_b16 v[54:55], v7 offset:27136
    s_add_u32 m0, s60, 40960
    s_add_u32 s11, s11, 262144
    buffer_load_dwordx4 v2, s[16:19], s11 offen sc1 lds
    s_waitcnt lgkmcnt(6)
    v_mfma_f32_32x32x16_bf16 v[32:47], v[240:243], v[60:63], v[32:47]
    ds_read_b64_tr_b16 v[56:57], v7 offset:28672
    ds_read_b64_tr_b16 v[58:59], v7 offset:29184
    s_waitcnt vmcnt(6)
    s_mov_b32 s59, 0
Lf_sc0:
    v_xor_b32 v80, s63, v97
    v_xor_b32 v81, s63, v99
    v_xor_b32 v82, s63, v105
    v_or3_b32 v80, v80, v81, v82
    v_cmp_ne_u32 vcc, 0, v80
    s_cmp_gt_u32 s59, 262144
    s_cbranch_scc1 Lf_sgo0
    s_cbranch_vccz Lf_sgo0
    s_add_u32 s59, s59, 1
    buffer_load_dwordx2 v[96:97], v10, s[16:19], s48 offen offset:0 sc1
    buffer_load_dwordx2 v[98:99], v10, s[16:19], s48 offen offset:512 sc1
    buffer_load_dwordx2 v[104:105], v10, s[16:19], s51 offen sc1
    s_waitcnt vmcnt(0)
    s_branch Lf_sc0
Lf_sgo0:
    v_cmp_eq_u32 vcc, 0, v8
    v_mov_b32 v105, 0
    s_mov_b32 s34, 0x01000100
    v_perm_b32 v108, v96, v96, s34
    v_and_b32 v92, 0xffff0000, v96
    v_cndmask_b32 v108, 0, v108, vcc
    v_rcp_f32 v93, v92
    v_mul_f32 v92, v92, v92
    v_mfma_f32_32x32x16_bf16 v[16:31], v[104:107], v[108:111], v[16:31]
    s_waitcnt lgkmcnt(6)
    v_mfma_f32_32x32x16_bf16 v[32:47], v[244:247], v[64:67], v[32:47]
    ds_read_b64_tr_b16 v[60:61], v7 offset:30720
    ds_read_b64_tr_b16 v[62:63], v7 offset:31232
    v_mul_f32 v94, v93, v93
    v_mul_f32 v94, v94, v93
    v_mul_f32 v93, 0xc0135761, v93
    v_mul_f32 v94, 0xbdd2d3e8, v94
    v_cndmask_b32 v112, v112, v118, s[28:29]
    v_cndmask_b32 v113, v113, v119, s[28:29]
    s_add_u32 m0, s60, 49152
    s_add_u32 s11, s11, 262144
    buffer_load_dwordx4 v2, s[16:19], s11 offen sc1 lds
    s_waitcnt lgkmcnt(6)
    v_mfma_f32_32x32x16_bf16 v[32:47], v[248:251], v[48:51], v[32:47]
    ds_read_b64_tr_b16 v[64:65], v7 offset:32768
    ds_read_b64_tr_b16 v[66:67], v7 offset:33280
    v_mul_f32 v80, v16, v16
    s_waitcnt lgkmcnt(6)
    v_mfma_f32_32x32x16_bf16 v[32:47], v[252:255], v[52:55], v[32:47]
    ds_read_b64_tr_b16 v[48:49], v7 offset:34816
    ds_read_b64_tr_b16 v[50:51], v7 offset:35328
    v_mul_f32 v81, v17, v17
    v_mul_f32 v82, v18, v18
    v_mul_f32 v83, v19, v19
    v_mul_f32 v84, v20, v20
    v_mul_f32 v85, v21, v21
    v_mul_f32 v86, v22, v22
    v_mul_f32 v87, v23, v23
    s_waitcnt lgkmcnt(6)
    v_mfma_f32_32x32x16_bf16 v[32:47], v[144:147], v[56:59], v[32:47]
    ds_read_b64_tr_b16 v[52:53], v7 offset:36864
    ds_read_b64_tr_b16 v[54:55], v7 offset:37376
    v_fma_f32 v80, v80, v94, v93
    v_fma_f32 v81, v81, v94, v93
    v_fma_f32 v82, v82, v94, v93
    v_fma_f32 v83, v83, v94, v93
    v_fma_f32 v84, v84, v94, v93
    s_add_u32 m0, s9, 0
    s_add_u32 s8, s8, 7168
    buffer_load_dwordx4 v3, s[20:23], s8 offen lds
    s_waitcnt lgkmcnt(6)
    v_mfma_f32_32x32x16_bf16 v[32:47], v[148:151], v[60:63], v[32:47]
    ds_read_b64_tr_b16 v[56:57], v7 offset:38912
    ds_read_b64_tr_b16 v[58:59], v7 offset:39424
    v_fma_f32 v85, v85, v94, v93
    v_fma_f32 v86, v86, v94, v93
    v_fma_f32 v87, v87, v94, v93
    v_mul_f32 v80, v80, v16
    v_mul_f32 v81, v81, v17
    s_add_u32 m0, s9, 1024
    s_add_u32 s8, s8, 7168
    buffer_load_dwordx4 v3, s[20:23], s8 offen lds
    s_waitcnt lgkmcnt(6)
    v_mfma_f32_32x32x16_bf16 v[32:47], v[152:155], v[64:67], v[32:47]
    ds_read_b64_tr_b16 v[60:61], v7 offset:40960
    ds_read_b64_tr_b16 v[62:63], v7 offset:41472
    v_mul_f32 v82, v82, v18
    v_mul_f32 v83, v83, v19
    v_mul_f32 v84, v84, v20
    v_mul_f32 v85, v85, v21
    v_mul_f32 v86, v86, v22
    v_mul_f32 v87, v87, v23
    v_exp_f32 v80, v80
    s_waitcnt lgkmcnt(6)
    v_mfma_f32_32x32x16_bf16 v[32:47], v[156:159], v[48:51], v[32:47]
    ds_read_b64_tr_b16 v[64:65], v7 offset:43008
    ds_read_b64_tr_b16 v[66:67], v7 offset:43520
    v_mul_f32 v24, v16, v24
    v_exp_f32 v81, v81
    v_mul_f32 v25, v17, v25
    v_exp_f32 v82, v82
    s_add_u32 m0, s9, 2048
    s_add_u32 s8, s8, 7168
    buffer_load_dwordx4 v3, s[20:23], s8 offen lds
    s_waitcnt lgkmcnt(6)
    v_mfma_f32_32x32x16_bf16 v[32:47], v[160:163], v[52:55], v[32:47]
    ds_read_b64_tr_b16 v[48:49], v7 offset:45056
    ds_read_b64_tr_b16 v[50:51], v7 offset:45568
    v_mul_f32 v26, v18, v26
    v_exp_f32 v83, v83
    v_mul_f32 v27, v19, v27
    v_exp_f32 v84, v84
    s_add_u32 m0, s9, 3072
    s_add_u32 s8, s8, 7168
    buffer_load_dwordx4 v3, s[20:23], s8 offen lds
    s_waitcnt lgkmcnt(6)
    v_mfma_f32_32x32x16_bf16 v[32:47], v[164:167], v[56:59], v[32:47]
    ds_read_b64_tr_b16 v[52:53], v7 offset:47104
    ds_read_b64_tr_b16 v[54:55], v7 offset:47616
    v_mul_f32 v28, v20, v28
    v_exp_f32 v85, v85
    v_mul_f32 v29, v21, v29
    v_exp_f32 v86, v86
    s_waitcnt lgkmcnt(6)
    v_mfma_f32_32x32x16_bf16 v[32:47], v[168:171], v[60:63], v[32:47]
    ds_read_b64_tr_b16 v[56:57], v7 offset:49152
    ds_read_b64_tr_b16 v[58:59], v7 offset:49664
    v_mul_f32 v30, v22, v30
    v_exp_f32 v87, v87
    v_mul_f32 v31, v23, v31
    v_fma_f32 v80, v80, v92, v92
    v_fma_f32 v81, v81, v92, v92
    s_add_u32 m0, s9, 4096
    s_add_u32 s8, s8, 7168
    buffer_load_dwordx4 v3, s[20:23], s8 offen lds
    s_waitcnt lgkmcnt(6)
    v_mfma_f32_32x32x16_bf16 v[32:47], v[172:175], v[64:67], v[32:47]
    ds_read_b64_tr_b16 v[60:61], v7 offset:51200
    ds_read_b64_tr_b16 v[62:63], v7 offset:51712
    v_rcp_f32 v80, v80
    v_fma_f32 v82, v82, v92, v92
    v_rcp_f32 v81, v81
    v_fma_f32 v83, v83, v92, v92
    s_add_u32 m0, s9, 5120
    s_add_u32 s8, s8, 7168
    buffer_load_dwordx4 v3, s[20:23], s8 offen lds
    s_waitcnt lgkmcnt(6)
    v_mfma_f32_32x32x16_bf16 v[32:47], v[176:179], v[48:51], v[32:47]
    ds_read_b64_tr_b16 v[64:65], v7 offset:53248
    ds_read_b64_tr_b16 v[66:67], v7 offset:53760
    v_rcp_f32 v82, v82
    v_fma_f32 v84, v84, v92, v92
    v_rcp_f32 v83, v83
    v_fma_f32 v85, v85, v92, v92
    s_waitcnt lgkmcnt(6)
    v_mfma_f32_32x32x16_bf16 v[32:47], v[180:183], v[52:55], v[32:47]
    ds_read_b64_tr_b16 v[48:49], v7 offset:55296
    ds_read_b64_tr_b16 v[50:51], v7 offset:55808
    v_rcp_f32 v84, v84
    v_fma_f32 v86, v86, v92, v92
    v_rcp_f32 v85, v85
    v_fma_f32 v87, v87, v92, v92
    s_waitcnt lgkmcnt(6)
    v_mfma_f32_32x32x16_bf16 v[32:47], v[184:187], v[56:59], v[32:47]
    s_waitcnt lgkmcnt(0)
    s_waitcnt vmcnt(6)
    s_barrier
    ds_read_b64_tr_b16 v[52:53], v6 offset:0
    ds_read_b64_tr_b16 v[54:55], v6 offset:512
    v_rcp_f32 v86, v86
    v_rcp_f32 v87, v87
    v_mul_f32 v80, v80, v24
    v_mul_f32 v81, v81, v25
    v_mfma_f32_32x32x16_bf16 v[32:47], v[188:191], v[60:63], v[32:47]
    ds_read_b64_tr_b16 v[56:57], v6 offset:2048
    ds_read_b64_tr_b16 v[58:59], v6 offset:2560
    v_mul_f32 v82, v82, v26
    v_mul_f32 v83, v83, v27
    v_mul_f32 v84, v84, v28
    v_mul_f32 v85, v85, v29
    v_mul_f32 v86, v86, v30
    v_mul_f32 v87, v87, v31
    v_mfma_f32_32x32x16_bf16 v[32:47], v[192:195], v[64:67], v[32:47]
    ds_read_b64_tr_b16 v[60:61], v6 offset:4096
    ds_read_b64_tr_b16 v[62:63], v6 offset:4608
    v_cvt_pk_bf16_f32 v88, v80, v81
    v_cvt_pk_bf16_f32 v89, v82, v83
    v_cvt_pk_bf16_f32 v90, v84, v85
    v_cvt_pk_bf16_f32 v91, v86, v87
    buffer_store_dwordx4 v[88:91], v11, s[16:19], s49 offen sc1
    s_add_u32 s49, s49, 229376
    s_add_u32 m0, s60, 57344
    s_add_u32 s11, s11, 4293394560
    buffer_load_dwordx4 v2, s[16:19], s11 offen sc1 lds
    v_mfma_f32_32x32x16_bf16 v[32:47], v[196:199], v[48:51], v[32:47]
    ds_read_b64_tr_b16 v[64:65], v6 offset:6144
    ds_read_b64_tr_b16 v[66:67], v6 offset:6656
    s_waitcnt lgkmcnt(6)
    v_mfma_f32_32x32x16_bf16 v[16:31], v[200:203], v[52:55], 0
    ds_read_b64_tr_b16 v[48:49], v6 offset:8192
    ds_read_b64_tr_b16 v[50:51], v6 offset:8704
    s_add_u32 m0, s60, 65536
    s_add_u32 s11, s11, 262144
    buffer_load_dwordx4 v2, s[16:19], s11 offen sc1 lds
    s_waitcnt lgkmcnt(6)
    v_mfma_f32_32x32x16_bf16 v[16:31], v[204:207], v[56:59], v[16:31]
    ds_read_b64_tr_b16 v[52:53], v6 offset:10240
    ds_read_b64_tr_b16 v[54:55], v6 offset:10752
    s_waitcnt lgkmcnt(6)
    v_mfma_f32_32x32x16_bf16 v[16:31], v[208:211], v[60:63], v[16:31]
    ds_read_b64_tr_b16 v[56:57], v6 offset:12288
    ds_read_b64_tr_b16 v[58:59], v6 offset:12800
    v_perm_b32 v108, v98, v98, s34
    v_and_b32 v92, 0xffff0000, v98
    v_cndmask_b32 v108, 0, v108, vcc
    v_rcp_f32 v93, v92
    v_mul_f32 v92, v92, v92
    s_add_u32 m0, s60, 73728
    s_add_u32 s11, s11, 262144
    buffer_load_dwordx4 v2, s[16:19], s11 offen sc1 lds
    s_waitcnt lgkmcnt(6)
    v_mfma_f32_32x32x16_bf16 v[16:31], v[212:215], v[64:67], v[16:31]
    ds_read_b64_tr_b16 v[60:61], v6 offset:14336
    ds_read_b64_tr_b16 v[62:63], v6 offset:14848
    v_mfma_f32_32x32x16_bf16 v[32:47], v[104:107], v[108:111], v[32:47]
    v_mul_f32 v94, v93, v93
    v_mul_f32 v94, v94, v93
    v_mul_f32 v93, 0xc0135761, v93
    v_mul_f32 v94, 0xbdd2d3e8, v94
    s_waitcnt lgkmcnt(6)
    v_mfma_f32_32x32x16_bf16 v[16:31], v[216:219], v[48:51], v[16:31]
    ds_read_b64_tr_b16 v[64:65], v6 offset:16384
    ds_read_b64_tr_b16 v[66:67], v6 offset:16896
    s_add_u32 m0, s60, 81920
    s_add_u32 s11, s11, 262144
    buffer_load_dwordx4 v2, s[16:19], s11 offen sc1 lds
    s_waitcnt lgkmcnt(6)
    v_mfma_f32_32x32x16_bf16 v[16:31], v[220:223], v[52:55], v[16:31]
    ds_read_b64_tr_b16 v[48:49], v6 offset:18432
    ds_read_b64_tr_b16 v[50:51], v6 offset:18944
    v_mul_f32 v80, v32, v32
    v_mul_f32 v81, v33, v33
    v_mul_f32 v82, v34, v34
    v_mul_f32 v83, v35, v35
    v_mul_f32 v84, v36, v36
    v_mul_f32 v85, v37, v37
    s_waitcnt lgkmcnt(6)
    v_mfma_f32_32x32x16_bf16 v[16:31], v[224:227], v[56:59], v[16:31]
    ds_read_b64_tr_b16 v[52:53], v6 offset:20480
    ds_read_b64_tr_b16 v[54:55], v6 offset:20992
    v_mul_f32 v86, v38, v38
    v_mul_f32 v87, v39, v39
    v_fma_f32 v80, v80, v94, v93
    v_fma_f32 v81, v81, v94, v93
    v_fma_f32 v82, v82, v94, v93
    v_fma_f32 v83, v83, v94, v93
    s_add_u32 m0, s60, 90112
    s_add_u32 s11, s11, 262144
    buffer_load_dwordx4 v2, s[16:19], s11 offen sc1 lds
    s_waitcnt lgkmcnt(6)
    v_mfma_f32_32x32x16_bf16 v[16:31], v[228:231], v[60:63], v[16:31]
    ds_read_b64_tr_b16 v[56:57], v6 offset:22528
    ds_read_b64_tr_b16 v[58:59], v6 offset:23040
    v_fma_f32 v84, v84, v94, v93
    v_fma_f32 v85, v85, v94, v93
    v_fma_f32 v86, v86, v94, v93
    v_fma_f32 v87, v87, v94, v93
    s_waitcnt lgkmcnt(6)
    v_mfma_f32_32x32x16_bf16 v[16:31], v[232:235], v[64:67], v[16:31]
    ds_read_b64_tr_b16 v[60:61], v6 offset:24576
    ds_read_b64_tr_b16 v[62:63], v6 offset:25088
    v_mul_f32 v80, v80, v32
    v_mul_f32 v81, v81, v33
    v_mul_f32 v82, v82, v34
    v_mul_f32 v83, v83, v35
    v_mul_f32 v84, v84, v36
    v_mul_f32 v85, v85, v37
    s_add_u32 m0, s60, 98304
    s_add_u32 s11, s11, 262144
    buffer_load_dwordx4 v2, s[16:19], s11 offen sc1 lds
    s_waitcnt lgkmcnt(6)
    v_mfma_f32_32x32x16_bf16 v[16:31], v[236:239], v[48:51], v[16:31]
    ds_read_b64_tr_b16 v[64:65], v6 offset:26624
    ds_read_b64_tr_b16 v[66:67], v6 offset:27136
    v_mul_f32 v86, v86, v38
    v_mul_f32 v87, v87, v39
    v_exp_f32 v80, v80
    v_mul_f32 v40, v32, v40
    v_exp_f32 v81, v81
    s_waitcnt lgkmcnt(6)
    v_mfma_f32_32x32x16_bf16 v[16:31], v[240:243], v[52:55], v[16:31]
    ds_read_b64_tr_b16 v[48:49], v6 offset:28672
    ds_read_b64_tr_b16 v[50:51], v6 offset:29184
    v_mul_f32 v41, v33, v41
    v_exp_f32 v82, v82
    v_mul_f32 v42, v34, v42
    v_exp_f32 v83, v83
    s_add_u32 m0, s60, 106496
    s_add_u32 s11, s11, 262144
    buffer_load_dwordx4 v2, s[16:19], s11 offen sc1 lds
    s_waitcnt vmcnt(12)
    ds_read_b64_tr_b16 v[68:69], v12 offset:0
    ds_read_b64_tr_b16 v[70:71], v12 offset:512
    s_waitcnt lgkmcnt(8)
    v_mfma_f32_32x32x16_bf16 v[16:31], v[244:247], v[56:59], v[16:31]
    ds_read_b64_tr_b16 v[52:53], v6 offset:30720
    ds_read_b64_tr_b16 v[54:55], v6 offset:31232
    v_mul_f32 v43, v35, v43
    v_exp_f32 v84, v84
    v_mul_f32 v44, v36, v44
    v_exp_f32 v85, v85
    ds_read_b64_tr_b16 v[72:73], v13 offset:0
    ds_read_b64_tr_b16 v[74:75], v13 offset:512
    s_waitcnt lgkmcnt(10)
    v_mfma_f32_32x32x16_bf16 v[16:31], v[248:251], v[60:63], v[16:31]
    ds_read_b64_tr_b16 v[56:57], v6 offset:32768
    ds_read_b64_tr_b16 v[58:59], v6 offset:33280
    v_mul_f32 v45, v37, v45
    v_exp_f32 v86, v86
    v_mul_f32 v46, v38, v46
    v_exp_f32 v87, v87
    s_waitcnt lgkmcnt(10)
    v_mfma_f32_32x32x16_bf16 v[16:31], v[252:255], v[64:67], v[16:31]
    ds_read_b64_tr_b16 v[60:61], v6 offset:34816
    ds_read_b64_tr_b16 v[62:63], v6 offset:35328
    s_waitcnt vmcnt(7)
    s_mov_b64 exec, 1
    buffer_store_dword v95, v4, s[16:19], s50 offen sc1
    s_mov_b64 exec, -1
    s_add_u32 s50, s50, 28672
    v_mul_f32 v47, v39, v47
    v_fma_f32 v80, v80, v92, v92
    v_fma_f32 v81, v81, v92, v92
    v_rcp_f32 v80, v80
    s_waitcnt lgkmcnt(10)
    v_mfma_f32_32x32x16_bf16 v[16:31], v[144:147], v[48:51], v[16:31]
    ds_read_b64_tr_b16 v[64:65], v6 offset:36864
    ds_read_b64_tr_b16 v[66:67], v6 offset:37376
    v_fma_f32 v82, v82, v92, v92
    v_rcp_f32 v81, v81
    v_fma_f32 v83, v83, v92, v92
    v_rcp_f32 v82, v82
    s_waitcnt lgkmcnt(8)
    v_mfma_f32_32x32x16_bf16 v[16:31], v[148:151], v[52:55], v[16:31]
    ds_read_b64_tr_b16 v[48:49], v6 offset:38912
    ds_read_b64_tr_b16 v[50:51], v6 offset:39424
    v_fma_f32 v84, v84, v92, v92
    v_rcp_f32 v83, v83
    v_fma_f32 v85, v85, v92, v92
    v_rcp_f32 v84, v84
    s_waitcnt lgkmcnt(6)
    v_mfma_f32_32x32x16_bf16 v[16:31], v[152:155], v[56:59], v[16:31]
    ds_read_b64_tr_b16 v[52:53], v6 offset:40960
    ds_read_b64_tr_b16 v[54:55], v6 offset:41472
    v_fma_f32 v86, v86, v92, v92
    v_rcp_f32 v85, v85
    v_fma_f32 v87, v87, v92, v92
    s_waitcnt lgkmcnt(6)
    v_mfma_f32_32x32x16_bf16 v[16:31], v[156:159], v[60:63], v[16:31]
    ds_read_b64_tr_b16 v[56:57], v6 offset:43008
    ds_read_b64_tr_b16 v[58:59], v6 offset:43520
    v_rcp_f32 v86, v86
    v_rcp_f32 v87, v87
    v_mul_f32 v80, v80, v40
    v_mul_f32 v81, v81, v41
    v_mul_f32 v82, v82, v42
    buffer_load_dwordx2 v[100:101], v10, s[16:19], s26 offen offset:0 sc1
    s_waitcnt lgkmcnt(6)
    v_mfma_f32_32x32x16_bf16 v[16:31], v[160:163], v[64:67], v[16:31]
    ds_read_b64_tr_b16 v[60:61], v6 offset:45056
    ds_read_b64_tr_b16 v[62:63], v6 offset:45568
    v_mul_f32 v83, v83, v43
    v_mul_f32 v84, v84, v44
    v_mul_f32 v85, v85, v45
    v_mul_f32 v86, v86, v46
    v_mul_f32 v87, v87, v47
    v_cvt_pk_bf16_f32 v88, v80, v81
    buffer_load_dwordx2 v[102:103], v10, s[16:19], s26 offen offset:512 sc1
    s_waitcnt lgkmcnt(6)
    v_mfma_f32_32x32x16_bf16 v[16:31], v[164:167], v[48:51], v[16:31]
    ds_read_b64_tr_b16 v[64:65], v6 offset:47104
    ds_read_b64_tr_b16 v[66:67], v6 offset:47616
    v_cvt_pk_bf16_f32 v89, v82, v83
    v_cvt_pk_bf16_f32 v90, v84, v85
    v_cvt_pk_bf16_f32 v91, v86, v87
    buffer_store_dwordx4 v[88:91], v11, s[16:19], s49 offen sc1
    s_add_u32 s49, s49, 3440640
    s_waitcnt lgkmcnt(6)
    v_mfma_f32_32x32x16_bf16 v[16:31], v[168:171], v[52:55], v[16:31]
    ds_read_b64_tr_b16 v[48:49], v6 offset:49152
    ds_read_b64_tr_b16 v[50:51], v6 offset:49664
    ds_read_b64_tr_b16 v[114:115], v116
    s_add_u32 m0, s9, 0
    s_add_u32 s8, s8, 7168
    buffer_load_dwordx4 v3, s[20:23], s8 offen lds
    s_waitcnt lgkmcnt(7)
    v_mfma_f32_32x32x16_bf16 v[16:31], v[172:175], v[56:59], v[16:31]
    ds_read_b64_tr_b16 v[52:53], v6 offset:51200
    ds_read_b64_tr_b16 v[54:55], v6 offset:51712
    s_add_u32 m0, s9, 1024
    s_add_u32 s8, s8, 7168
    buffer_load_dwordx4 v3, s[20:23], s8 offen lds
    s_waitcnt lgkmcnt(7)
    v_mfma_f32_32x32x16_bf16 v[16:31], v[176:179], v[60:63], v[16:31]
    ds_read_b64_tr_b16 v[56:57], v6 offset:53248
    ds_read_b64_tr_b16 v[58:59], v6 offset:53760
    s_waitcnt lgkmcnt(7)
    v_mfma_f32_32x32x16_bf16 v[16:31], v[180:183], v[64:67], v[16:31]
    ds_read_b64_tr_b16 v[60:61], v6 offset:55296
    ds_read_b64_tr_b16 v[62:63], v6 offset:55808
    s_waitcnt lgkmcnt(7)
    v_mfma_f32_32x32x16_bf16 v[16:31], v[184:187], v[48:51], v[16:31]
    s_waitcnt lgkmcnt(0)
    s_waitcnt vmcnt(6)
    s_barrier
    ds_read_b64_tr_b16 v[64:65], v7 offset:0
    ds_read_b64_tr_b16 v[66:67], v7 offset:512
    v_mfma_f32_32x32x16_bf16 v[16:31], v[188:191], v[52:55], v[16:31]
    ds_read_b64_tr_b16 v[48:49], v7 offset:2048
    ds_read_b64_tr_b16 v[50:51], v7 offset:2560
    s_add_u32 m0, s10, 0
    s_add_u32 s8, s8, 7168
    buffer_load_dwordx4 v3, s[20:23], s8 offen lds
    v_mfma_f32_32x32x16_bf16 v[16:31], v[192:195], v[56:59], v[16:31]
    ds_read_b64_tr_b16 v[52:53], v7 offset:4096
    ds_read_b64_tr_b16 v[54:55], v7 offset:4608
    s_add_u32 m0, s10, 1024
    s_add_u32 s8, s8, 7168
    buffer_load_dwordx4 v3, s[20:23], s8 offen lds
    v_mfma_f32_32x32x16_bf16 v[16:31], v[196:199], v[60:63], v[16:31]
    ds_read_b64_tr_b16 v[56:57], v7 offset:6144
    ds_read_b64_tr_b16 v[58:59], v7 offset:6656
    s_add_u32 m0, s10, 2048
    s_add_u32 s8, s8, 7168
    buffer_load_dwordx4 v3, s[20:23], s8 offen lds
    s_waitcnt lgkmcnt(6)
    v_mfma_f32_32x32x16_bf16 v[32:47], v[200:203], v[64:67], 0
    ds_read_b64_tr_b16 v[60:61], v7 offset:8192
    ds_read_b64_tr_b16 v[62:63], v7 offset:8704
    s_add_u32 m0, s10, 3072
    s_add_u32 s8, s8, 7168
    buffer_load_dwordx4 v3, s[20:23], s8 offen lds
    s_waitcnt lgkmcnt(6)
    v_mfma_f32_32x32x16_bf16 v[32:47], v[204:207], v[48:51], v[32:47]
    ds_read_b64_tr_b16 v[64:65], v7 offset:10240
    ds_read_b64_tr_b16 v[66:67], v7 offset:10752
    s_waitcnt lgkmcnt(6)
    v_mfma_f32_32x32x16_bf16 v[32:47], v[208:211], v[52:55], v[32:47]
    ds_read_b64_tr_b16 v[48:49], v7 offset:12288
    ds_read_b64_tr_b16 v[50:51], v7 offset:12800
    s_waitcnt vmcnt(7)
    s_mov_b32 s59, 0
Lf_sc1:
    v_xor_b32 v80, s63, v101
    v_xor_b32 v81, s63, v103
    v_xor_b32 v82, s63, v103
    v_or3_b32 v80, v80, v81, v82
    v_cmp_ne_u32 vcc, 0, v80
    s_cmp_gt_u32 s59, 262144
    s_cbranch_scc1 Lf_sgo1
    s_cbranch_vccz Lf_sgo1
    s_add_u32 s59, s59, 1
    buffer_load_dwordx2 v[100:101], v10, s[16:19], s26 offen offset:0 sc1
    buffer_load_dwordx2 v[102:103], v10, s[16:19], s26 offen offset:512 sc1
    s_waitcnt vmcnt(0)
    s_branch Lf_sc1
Lf_sgo1:
    v_cmp_eq_u32 vcc, 0, v8
    v_perm_b32 v108, v100, v100, s34
    v_and_b32 v92, 0xffff0000, v100
    v_cndmask_b32 v108, 0, v108, vcc
    v_rcp_f32 v93, v92
    v_mul_f32 v92, v92, v92
    s_add_u32 m0, s10, 4096
    s_add_u32 s8, s8, 7168
    buffer_load_dwordx4 v3, s[20:23], s8 offen lds
    ds_read_b64_tr_b16 v[200:201], v12 offset:2048
    ds_read_b64_tr_b16 v[202:203], v12 offset:2560
    s_waitcnt lgkmcnt(8)
    v_mfma_f32_32x32x16_bf16 v[32:47], v[212:215], v[56:59], v[32:47]
    ds_read_b64_tr_b16 v[52:53], v7 offset:14336
    ds_read_b64_tr_b16 v[54:55], v7 offset:14848
    v_mfma_f32_32x32x16_bf16 v[16:31], v[104:107], v[108:111], v[16:31]
    v_mul_f32 v94, v93, v93
    v_mul_f32 v94, v94, v93
    v_mul_f32 v93, 0xc0135761, v93
    v_mul_f32 v94, 0xbdd2d3e8, v94
    s_add_u32 m0, s10, 5120
    s_add_u32 s8, s8, 7168
    buffer_load_dwordx4 v3, s[20:23], s8 offen lds
    ds_read_b64_tr_b16 v[204:205], v13 offset:2048
    ds_read_b64_tr_b16 v[206:207], v13 offset:2560
    s_waitcnt lgkmcnt(10)
    v_mfma_f32_32x32x16_bf16 v[32:47], v[216:219], v[60:63], v[32:47]
    ds_read_b64_tr_b16 v[56:57], v7 offset:16384
    ds_read_b64_tr_b16 v[58:59], v7 offset:16896
    s_cmp_lt_u32 s36, 4
    s_cbranch_scc1 Lf_np
    s_setprio 1
Lf_np:
    s_waitcnt lgkmcnt(10)
    v_mfma_f32_32x32x16_bf16 v[32:47], v[220:223], v[64:67], v[32:47]
    ds_read_b64_tr_b16 v[60:61], v7 offset:18432
    ds_read_b64_tr_b16 v[62:63], v7 offset:18944
    v_mul_f32 v80, v16, v16
    v_mul_f32 v81, v17, v17
    v_mul_f32 v82, v18, v18
    v_mul_f32 v83, v19, v19
    v_mul_f32 v84, v20, v20
    v_mul_f32 v85, v21, v21
    ds_read_b64_tr_b16 v[118:119], v116 offset:57344
    ds_read_b64_tr_b16 v[208:209], v12 offset:4096
    ds_read_b64_tr_b16 v[210:211], v12 offset:4608
    s_waitcnt lgkmcnt(13)
    v_mfma_f32_32x32x16_bf16 v[32:47], v[224:227], v[48:51], v[32:47]
    ds_read_b64_tr_b16 v[64:65], v7 offset:20480
    ds_read_b64_tr_b16 v[66:67], v7 offset:20992
    s_waitcnt vmcnt(8)
    s_mov_b64 exec, 1
    buffer_store_dword v95, v4, s[16:19], s50 offen sc1
    s_mov_b64 exec, -1
    s_add_u32 s50, s50, 430080
    v_mul_f32 v86, v22, v22
    v_mul_f32 v87, v23, v23
    v_fma_f32 v80, v80, v94, v93
    v_fma_f32 v81, v81, v94, v93
    v_fma_f32 v82, v82, v94, v93
    v_fma_f32 v83, v83, v94, v93
    s_add_u32 m0, s9, 2048
    s_waitcnt lgkmcnt(9)
    s_add_u32 s8, s8, 7168
    buffer_load_dwordx4 v3, s[20:23], s8 offen lds
    ds_read_b64_tr_b16 v[212:213], v13 offset:4096
    ds_read_b64_tr_b16 v[214:215], v13 offset:4608
    v_mfma_f32_32x32x16_bf16 v[32:47], v[228:231], v[52:55], v[32:47]
    ds_read_b64_tr_b16 v[48:49], v7 offset:22528
    ds_read_b64_tr_b16 v[50:51], v7 offset:23040
    v_fma_f32 v84, v84, v94, v93
    v_fma_f32 v85, v85, v94, v93
    v_fma_f32 v86, v86, v94, v93
    v_fma_f32 v87, v87, v94, v93
    s_add_u32 m0, s9, 3072
    s_add_u32 s8, s8, 7168
    buffer_load_dwordx4 v3, s[20:23], s8 offen lds
    s_waitcnt lgkmcnt(11)
    v_mfma_f32_32x32x16_bf16 v[32:47], v[232:235], v[56:59], v[32:47]
    ds_read_b64_tr_b16 v[52:53], v7 offset:24576
    ds_read_b64_tr_b16 v[54:55], v7 offset:25088
    v_mul_f32 v80, v80, v16
    v_mul_f32 v81, v81, v17
    v_mul_f32 v82, v82, v18
    v_mul_f32 v83, v83, v19
    v_mul_f32 v84, v84, v20
    v_mul_f32 v85, v85, v21
    s_waitcnt vmcnt(9)
    ds_read_b64_tr_b16 v[216:217], v12 offset:0
    ds_read_b64_tr_b16 v[218:219], v12 offset:512
    s_waitcnt lgkmcnt(13)
    v_mfma_f32_32x32x16_bf16 v[32:47], v[236:239], v[60:63], v[32:47]
    ds_read_b64_tr_b16 v[56:57], v7 offset:26624
    ds_read_b64_tr_b16 v[58:59], v7 offset:27136
    v_mul_f32 v86, v86, v22
    v_mul_f32 v87, v87, v23
    v_exp_f32 v80, v80
    v_mul_f32 v24, v16, v24
    v_exp_f32 v81, v81
    s_add_u32 m0, s9, 4096
    s_waitcnt lgkmcnt(8)
    s_add_u32 s8, s8, 7168
    buffer_load_dwordx4 v3, s[20:23], s8 offen lds
    ds_read_b64_tr_b16 v[220:221], v13 offset:0
    ds_read_b64_tr_b16 v[222:223], v13 offset:512
    v_mfma_f32_32x32x16_bf16 v[32:47], v[240:243], v[64:67], v[32:47]
    ds_read_b64_tr_b16 v[60:61], v7 offset:28672
    ds_read_b64_tr_b16 v[62:63], v7 offset:29184
    v_mul_f32 v25, v17, v25
    v_exp_f32 v82, v82
    v_mul_f32 v26, v18, v26
    v_exp_f32 v83, v83
    s_add_u32 m0, s9, 5120
    s_add_u32 s8, s8, 7168
    buffer_load_dwordx4 v3, s[20:23], s8 offen lds
    s_waitcnt lgkmcnt(10)
    v_mfma_f32_32x32x16_bf16 v[32:47], v[244:247], v[48:51], v[32:47]
    ds_read_b64_tr_b16 v[64:65], v7 offset:30720
    ds_read_b64_tr_b16 v[66:67], v7 offset:31232
    v_mul_f32 v27, v19, v27
    v_exp_f32 v84, v84
    v_mul_f32 v28, v20, v28
    v_exp_f32 v85, v85
    v_cndmask_b32 v114, v114, v118, s[28:29]
    v_cndmask_b32 v115, v115, v119, s[28:29]
    s_waitcnt lgkmcnt(10)
    v_mfma_f32_32x32x16_bf16 v[32:47], v[248:251], v[52:55], v[32:47]
    ds_read_b64_tr_b16 v[48:49], v7 offset:32768
    ds_read_b64_tr_b16 v[50:51], v7 offset:33280
    v_mul_f32 v29, v21, v29
    v_exp_f32 v86, v86
    v_mul_f32 v30, v22, v30
    v_exp_f32 v87, v87
    s_add_u32 m0, s9, 0
    s_waitcnt lgkmcnt(6)
    s_add_u32 s8, s8, 7168
    buffer_load_dwordx4 v3, s[20:23], s8 offen lds
    v_mfma_f32_32x32x16_bf16 v[32:47], v[252:255], v[56:59], v[32:47]
    ds_read_b64_tr_b16 v[52:53], v7 offset:34816
    ds_read_b64_tr_b16 v[54:55], v7 offset:35328
    v_mul_f32 v31, v23, v31
    v_fma_f32 v80, v80, v92, v92
    v_fma_f32 v81, v81, v92, v92
    v_rcp_f32 v80, v80
    s_add_u32 m0, s9, 1024
    s_add_u32 s8, s8, 7168
    buffer_load_dwordx4 v3, s[20:23], s8 offen lds
    s_waitcnt vmcnt(11)
    ds_read_b64_tr_b16 v[224:225], v14 offset:0
    ds_read_b64_tr_b16 v[226:227], v14 offset:512
    s_waitcnt lgkmcnt(8)
    v_mfma_f32_32x32x16_bf16 v[32:47], v[144:147], v[60:63], v[32:47]
    ds_read_b64_tr_b16 v[56:57], v7 offset:36864
    ds_read_b64_tr_b16 v[58:59], v7 offset:37376
    v_fma_f32 v82, v82, v92, v92
    v_rcp_f32 v81, v81
    v_fma_f32 v83, v83, v92, v92
    v_rcp_f32 v82, v82
    ds_read_b64_tr_b16 v[228:229], v15 offset:0
    ds_read_b64_tr_b16 v[230:231], v15 offset:512
    s_waitcnt lgkmcnt(10)
    v_mfma_f32_32x32x16_bf16 v[32:47], v[148:151], v[64:67], v[32:47]
    ds_read_b64_tr_b16 v[60:61], v7 offset:38912
    ds_read_b64_tr_b16 v[62:63], v7 offset:39424
    v_fma_f32 v84, v84, v92, v92
    v_rcp_f32 v83, v83
    v_fma_f32 v85, v85, v92, v92
    v_rcp_f32 v84, v84
    s_waitcnt lgkmcnt(10)
    v_mfma_f32_32x32x16_bf16 v[32:47], v[152:155], v[48:51], v[32:47]
    ds_read_b64_tr_b16 v[64:65], v7 offset:40960
    ds_read_b64_tr_b16 v[66:67], v7 offset:41472
    v_fma_f32 v86, v86, v92, v92
    v_rcp_f32 v85, v85
    v_fma_f32 v87, v87, v92, v92
    s_add_u32 m0, s10, 0
    s_waitcnt lgkmcnt(4)
    s_add_u32 s8, s8, 7168
    buffer_load_dwordx4 v3, s[20:23], s8 offen lds
    v_mfma_f32_32x32x16_bf16 v[32:47], v[156:159], v[52:55], v[32:47]
    ds_read_b64_tr_b16 v[48:49], v7 offset:43008
    ds_read_b64_tr_b16 v[50:51], v7 offset:43520
    v_rcp_f32 v86, v86
    v_rcp_f32 v87, v87
    v_mul_f32 v80, v80, v24
    v_mul_f32 v81, v81, v25
    v_mul_f32 v82, v82, v26
    s_add_u32 m0, s10, 1024
    s_add_u32 s8, s8, 7168
    buffer_load_dwordx4 v3, s[20:23], s8 offen lds
    v_mfma_f32_32x32x16_bf16 v[32:47], v[160:163], v[56:59], v[32:47]
    ds_read_b64_tr_b16 v[52:53], v7 offset:45056
    ds_read_b64_tr_b16 v[54:55], v7 offset:45568
    v_mul_f32 v83, v83, v27
    v_mul_f32 v84, v84, v28
    v_mul_f32 v85, v85, v29
    v_mul_f32 v86, v86, v30
    v_mul_f32 v87, v87, v31
    v_cvt_pk_bf16_f32 v88, v80, v81
    s_waitcnt lgkmcnt(6)
    v_mfma_f32_32x32x16_bf16 v[32:47], v[164:167], v[60:63], v[32:47]
    ds_read_b64_tr_b16 v[56:57], v7 offset:47104
    ds_read_b64_tr_b16 v[58:59], v7 offset:47616
    v_cvt_pk_bf16_f32 v89, v82, v83
    v_cvt_pk_bf16_f32 v90, v84, v85
    v_cvt_pk_bf16_f32 v91, v86, v87
    buffer_store_dwordx4 v[88:91], v11, s[16:19], s49 offen sc1
    s_add_u32 s49, s49, 229376
    s_waitcnt lgkmcnt(6)
    v_mfma_f32_32x32x16_bf16 v[32:47], v[168:171], v[64:67], v[32:47]
    ds_read_b64_tr_b16 v[60:61], v7 offset:49152
    ds_read_b64_tr_b16 v[62:63], v7 offset:49664
    s_waitcnt lgkmcnt(6)
    v_mfma_f32_32x32x16_bf16 v[32:47], v[172:175], v[48:51], v[32:47]
    ds_read_b64_tr_b16 v[64:65], v7 offset:51200
    ds_read_b64_tr_b16 v[66:67], v7 offset:51712
    s_waitcnt lgkmcnt(6)
    v_mfma_f32_32x32x16_bf16 v[32:47], v[176:179], v[52:55], v[32:47]
    ds_read_b64_tr_b16 v[48:49], v7 offset:53248
    ds_read_b64_tr_b16 v[50:51], v7 offset:53760
    s_waitcnt lgkmcnt(6)
    v_mfma_f32_32x32x16_bf16 v[32:47], v[180:183], v[56:59], v[32:47]
    ds_read_b64_tr_b16 v[52:53], v7 offset:55296
    ds_read_b64_tr_b16 v[54:55], v7 offset:55808
    s_waitcnt lgkmcnt(6)
    v_mfma_f32_32x32x16_bf16 v[32:47], v[184:187], v[60:63], v[32:47]
    s_waitcnt lgkmcnt(4)
    v_mfma_f32_32x32x16_bf16 v[32:47], v[188:191], v[64:67], v[32:47]
    s_waitcnt lgkmcnt(2)
    v_mfma_f32_32x32x16_bf16 v[32:47], v[192:195], v[48:51], v[32:47]
    s_waitcnt lgkmcnt(0)
    v_mfma_f32_32x32x16_bf16 v[32:47], v[196:199], v[52:55], v[32:47]
    s_setprio 0
    v_perm_b32 v108, v102, v102, s34
    v_and_b32 v92, 0xffff0000, v102
    v_cndmask_b32 v108, 0, v108, vcc
    v_rcp_f32 v93, v92
    v_mul_f32 v92, v92, v92
    v_mfma_f32_32x32x16_bf16 v[32:47], v[104:107], v[108:111], v[32:47]
    v_mul_f32 v94, v93, v93
    v_mul_f32 v94, v94, v93
    v_mul_f32 v93, 0xc0135761, v93
    v_mul_f32 v94, 0xbdd2d3e8, v94
    s_nop 7
    v_pk_mul_f32 v[80:81], v[32:33], v[32:33]
    v_pk_mul_f32 v[82:83], v[34:35], v[34:35]
    v_pk_mul_f32 v[84:85], v[36:37], v[36:37]
    v_pk_mul_f32 v[86:87], v[38:39], v[38:39]
    v_pk_fma_f32 v[80:81], v[80:81], v[94:95], v[92:93] op_sel:[0,0,1] op_sel_hi:[1,0,1]
    v_pk_fma_f32 v[82:83], v[82:83], v[94:95], v[92:93] op_sel:[0,0,1] op_sel_hi:[1,0,1]
    v_pk_fma_f32 v[84:85], v[84:85], v[94:95], v[92:93] op_sel:[0,0,1] op_sel_hi:[1,0,1]
    v_pk_fma_f32 v[86:87], v[86:87], v[94:95], v[92:93] op_sel:[0,0,1] op_sel_hi:[1,0,1]
    v_pk_mul_f32 v[80:81], v[80:81], v[32:33]
    v_pk_mul_f32 v[82:83], v[82:83], v[34:35]
    v_pk_mul_f32 v[84:85], v[84:85], v[36:37]
    v_pk_mul_f32 v[86:87], v[86:87], v[38:39]
    v_exp_f32 v80, v80
    s_waitcnt vmcnt(0)
    s_mov_b64 exec, 1
    buffer_store_dword v95, v4, s[16:19], s50 offen sc1
    s_mov_b64 exec, -1
    s_add_u32 s50, s50, 28672
    buffer_load_dword v118, v9, s[16:19], s33 offen sc1
    v_exp_f32 v81, v81
    v_exp_f32 v82, v82
    v_exp_f32 v83, v83
    v_exp_f32 v84, v84
    v_exp_f32 v85, v85
    v_exp_f32 v86, v86
    v_exp_f32 v87, v87
    v_pk_mul_f32 v[40:41], v[32:33], v[40:41]
    v_pk_mul_f32 v[42:43], v[34:35], v[42:43]
    v_pk_mul_f32 v[44:45], v[36:37], v[44:45]
    v_pk_mul_f32 v[46:47], v[38:39], v[46:47]
    v_pk_fma_f32 v[80:81], v[80:81], v[92:93], v[92:93] op_sel_hi:[1,0,0]
    v_pk_fma_f32 v[82:83], v[82:83], v[92:93], v[92:93] op_sel_hi:[1,0,0]
    v_pk_fma_f32 v[84:85], v[84:85], v[92:93], v[92:93] op_sel_hi:[1,0,0]
    v_pk_fma_f32 v[86:87], v[86:87], v[92:93], v[92:93] op_sel_hi:[1,0,0]
    v_rcp_f32 v80, v80
    v_rcp_f32 v81, v81
    v_rcp_f32 v82, v82
    v_rcp_f32 v83, v83
    v_rcp_f32 v84, v84
    v_rcp_f32 v85, v85
    v_rcp_f32 v86, v86
    v_rcp_f32 v87, v87
    v_pk_mul_f32 v[80:81], v[80:81], v[40:41]
    v_pk_mul_f32 v[82:83], v[82:83], v[42:43]
    v_pk_mul_f32 v[84:85], v[84:85], v[44:45]
    v_pk_mul_f32 v[86:87], v[86:87], v[46:47]
    v_cvt_pk_bf16_f32 v88, v80, v81
    v_cvt_pk_bf16_f32 v89, v82, v83
    v_cvt_pk_bf16_f32 v90, v84, v85
    v_cvt_pk_bf16_f32 v91, v86, v87
    buffer_store_dwordx4 v[88:91], v11, s[16:19], s49 offen sc1
    s_add_u32 s49, s49, 229376
    s_waitcnt vmcnt(1)
    s_mov_b32 s59, 0
Lf_pec:
    v_cmp_ne_u32 s[56:57], s63, v118
    s_cmp_gt_u32 s59, 262144
    s_cbranch_scc1 Lf_pego
    s_cmp_eq_u64 s[56:57], 0
    s_cbranch_scc1 Lf_pego
    buffer_load_dword v118, v9, s[16:19], s33 offen sc1
    s_add_u32 s59, s59, 1
    s_waitcnt vmcnt(0)
    s_branch Lf_pec
Lf_pego:
    s_add_u32 s33, s33, 458752
    buffer_load_dwordx4 v[48:51], v11, s[16:19], s32 offen offset:0 sc1
    buffer_load_dwordx4 v[52:55], v11, s[16:19], s32 offen offset:1024 sc1
    buffer_load_dwordx4 v[56:59], v11, s[16:19], s32 offen offset:2048 sc1
    buffer_load_dwordx4 v[60:63], v11, s[16:19], s32 offen offset:3072 sc1
    s_add_u32 s32, s32, 4096
    buffer_load_dwordx4 v[64:67], v11, s[16:19], s32 offen offset:0 sc1
    buffer_load_dwordx4 v[76:79], v11, s[16:19], s32 offen offset:1024 sc1
    ds_read_b64_tr_b16 v[232:233], v14 offset:2048
    ds_read_b64_tr_b16 v[234:235], v14 offset:2560
    ds_read_b64_tr_b16 v[236:237], v15 offset:2048
    ds_read_b64_tr_b16 v[238:239], v15 offset:2560
    ds_read_b64_tr_b16 v[240:241], v14 offset:4096
    ds_read_b64_tr_b16 v[242:243], v14 offset:4608
    ds_read_b64_tr_b16 v[244:245], v15 offset:4096
    ds_read_b64_tr_b16 v[246:247], v15 offset:4608
    ds_read_b64_tr_b16 v[248:249], v12 offset:2048
    ds_read_b64_tr_b16 v[250:251], v12 offset:2560
    ds_read_b64_tr_b16 v[252:253], v13 offset:2048
    ds_read_b64_tr_b16 v[254:255], v13 offset:2560
    ds_read_b64_tr_b16 v[144:145], v12 offset:4096
    ds_read_b64_tr_b16 v[146:147], v12 offset:4608
    ds_read_b64_tr_b16 v[148:149], v13 offset:4096
    s_waitcnt lgkmcnt(11)
    ds_read_b64_tr_b16 v[150:151], v13 offset:4608
    ds_read_b64_tr_b16 v[152:153], v12 offset:0
    ds_read_b64_tr_b16 v[154:155], v12 offset:512
    ds_read_b64_tr_b16 v[156:157], v13 offset:0
    s_waitcnt lgkmcnt(11)
    ds_read_b64_tr_b16 v[158:159], v13 offset:512
    ds_read_b64_tr_b16 v[160:161], v14 offset:0
    ds_read_b64_tr_b16 v[162:163], v14 offset:512
    ds_read_b64_tr_b16 v[164:165], v15 offset:0
    s_waitcnt lgkmcnt(11)
    ds_read_b64_tr_b16 v[166:167], v15 offset:512
    s_waitcnt vmcnt(6)
    s_mov_b64 exec, 1
    buffer_store_dword v95, v4, s[16:19], s50 offen sc1
    s_mov_b64 exec, -1
    s_add_u32 s50, s50, 28672
    s_waitcnt lgkmcnt(0)
    s_barrier
    buffer_load_dwordx4 v[168:171], v11, s[16:19], s32 offen offset:2048 sc1
    buffer_load_dwordx4 v[172:175], v11, s[16:19], s32 offen offset:3072 sc1
    s_add_u32 s32, s32, 4096
    buffer_load_dwordx4 v[176:179], v11, s[16:19], s32 offen offset:0 sc1
    buffer_load_dwordx4 v[180:183], v11, s[16:19], s32 offen offset:1024 sc1
    buffer_load_dwordx4 v[184:187], v11, s[16:19], s32 offen offset:2048 sc1
    buffer_load_dwordx4 v[188:191], v11, s[16:19], s32 offen offset:3072 sc1
    s_add_u32 s32, s32, 4096
    buffer_load_dwordx4 v[192:195], v11, s[16:19], s32 offen offset:0 sc1
    buffer_load_dwordx4 v[196:199], v11, s[16:19], s32 offen offset:1024 sc1
    s_add_u32 s32, s32, 3657728
    s_mul_i32 s3, s36, 7168
    v_add_u32 v2, s3, v11
    s_xor_b32 s3, s36, 1
    s_mul_i32 s3, s3, 7168
    v_add_u32 v3, s3, v11
    s_xor_b32 s3, s36, 2
    s_mul_i32 s3, s3, 7168
    v_add_u32 v5, s3, v11
    s_xor_b32 s3, s36, 3
    s_mul_i32 s3, s3, 7168
    v_add_u32 v6, s3, v11
    s_xor_b32 s3, s36, 4
    s_mul_i32 s3, s3, 7168
    v_add_u32 v7, s3, v11
    s_xor_b32 s3, s36, 5
    s_mul_i32 s3, s3, 7168
    v_add_u32 v8, s3, v11
    s_xor_b32 s3, s36, 6
    s_mul_i32 s3, s3, 7168
    v_add_u32 v10, s3, v11
    s_xor_b32 s3, s36, 7
    s_mul_i32 s3, s3, 7168
    v_add_u32 v116, s3, v11
    buffer_load_dword v118, v9, s[16:19], s33 offen sc1
    s_waitcnt vmcnt(15)
    v_mfma_f32_32x32x16_bf16 v[16:31], v[120:123], v[48:51], 0
    v_mfma_f32_32x32x16_bf16 v[32:47], v[124:127], v[48:51], 0
    s_waitcnt vmcnt(14)
    v_mfma_f32_32x32x16_bf16 v[16:31], v[128:131], v[52:55], v[16:31]
    v_mfma_f32_32x32x16_bf16 v[32:47], v[132:135], v[52:55], v[32:47]
    s_waitcnt vmcnt(13)
    v_mfma_f32_32x32x16_bf16 v[16:31], v[136:139], v[56:59], v[16:31]
    v_mfma_f32_32x32x16_bf16 v[32:47], v[140:143], v[56:59], v[32:47]
    s_waitcnt vmcnt(12)
    v_mfma_f32_32x32x16_bf16 v[16:31], v[68:71], v[60:63], v[16:31]
    v_mfma_f32_32x32x16_bf16 v[32:47], v[72:75], v[60:63], v[32:47]
    s_waitcnt vmcnt(11)
    v_mfma_f32_32x32x16_bf16 v[16:31], v[200:203], v[64:67], v[16:31]
    v_mfma_f32_32x32x16_bf16 v[32:47], v[204:207], v[64:67], v[32:47]
    s_waitcnt vmcnt(10)
    v_mfma_f32_32x32x16_bf16 v[16:31], v[208:211], v[76:79], v[16:31]
    v_mfma_f32_32x32x16_bf16 v[32:47], v[212:215], v[76:79], v[32:47]
    s_waitcnt vmcnt(8)
    v_mfma_f32_32x32x16_bf16 v[16:31], v[216:219], v[168:171], v[16:31]
    v_mfma_f32_32x32x16_bf16 v[32:47], v[220:223], v[168:171], v[32:47]
    s_waitcnt vmcnt(7)
    v_mfma_f32_32x32x16_bf16 v[16:31], v[224:227], v[172:175], v[16:31]
    v_mfma_f32_32x32x16_bf16 v[32:47], v[228:231], v[172:175], v[32:47]
    s_waitcnt vmcnt(6)
    v_mfma_f32_32x32x16_bf16 v[16:31], v[232:235], v[176:179], v[16:31]
    v_mfma_f32_32x32x16_bf16 v[32:47], v[236:239], v[176:179], v[32:47]
    s_waitcnt vmcnt(5)
    v_mfma_f32_32x32x16_bf16 v[16:31], v[240:243], v[180:183], v[16:31]
    v_mfma_f32_32x32x16_bf16 v[32:47], v[244:247], v[180:183], v[32:47]
    s_waitcnt vmcnt(4)
    v_mfma_f32_32x32x16_bf16 v[16:31], v[248:251], v[184:187], v[16:31]
    v_mfma_f32_32x32x16_bf16 v[32:47], v[252:255], v[184:187], v[32:47]
    s_waitcnt vmcnt(3)
    v_mfma_f32_32x32x16_bf16 v[16:31], v[144:147], v[188:191], v[16:31]
    v_mfma_f32_32x32x16_bf16 v[32:47], v[148:151], v[188:191], v[32:47]
    s_waitcnt vmcnt(2)
    v_mfma_f32_32x32x16_bf16 v[16:31], v[152:155], v[192:195], v[16:31]
    v_mfma_f32_32x32x16_bf16 v[32:47], v[156:159], v[192:195], v[32:47]
    s_waitcnt vmcnt(1)
    v_mfma_f32_32x32x16_bf16 v[16:31], v[160:163], v[196:199], v[16:31]
    v_mfma_f32_32x32x16_bf16 v[32:47], v[164:167], v[196:199], v[32:47]
    s_waitcnt vmcnt(0)
    s_mov_b32 s59, 0
Lf_plc:
    v_cmp_ne_u32 s[56:57], s63, v118
    s_cmp_gt_u32 s59, 262144
    s_cbranch_scc1 Lf_plgo
    s_cmp_eq_u64 s[56:57], 0
    s_cbranch_scc1 Lf_plgo
    buffer_load_dword v118, v9, s[16:19], s33 offen sc1
    s_add_u32 s59, s59, 1
    s_waitcnt vmcnt(0)
    s_branch Lf_plc
Lf_plgo:
    s_add_u32 s33, s33, 458752
    buffer_load_dwordx4 v[48:51], v11, s[16:19], s32 offen offset:0 sc1
    buffer_load_dwordx4 v[52:55], v11, s[16:19], s32 offen offset:1024 sc1
    buffer_load_dwordx4 v[56:59], v11, s[16:19], s32 offen offset:2048 sc1
    buffer_load_dwordx4 v[60:63], v11, s[16:19], s32 offen offset:3072 sc1
    s_add_u32 s32, s32, 4096
    buffer_load_dwordx4 v[64:67], v11, s[16:19], s32 offen offset:0 sc1
    buffer_load_dwordx4 v[76:79], v11, s[16:19], s32 offen offset:1024 sc1
    buffer_load_dwordx4 v[168:171], v11, s[16:19], s32 offen offset:2048 sc1
    buffer_load_dwordx4 v[172:175], v11, s[16:19], s32 offen offset:3072 sc1
    s_add_u32 s32, s32, 4096
    buffer_load_dwordx4 v[176:179], v11, s[16:19], s32 offen offset:0 sc1
    buffer_load_dwordx4 v[180:183], v11, s[16:19], s32 offen offset:1024 sc1
    buffer_load_dwordx4 v[184:187], v11, s[16:19], s32 offen offset:2048 sc1
    buffer_load_dwordx4 v[188:191], v11, s[16:19], s32 offen offset:3072 sc1
    s_add_u32 s32, s32, 4096
    buffer_load_dwordx4 v[192:195], v11, s[16:19], s32 offen offset:0 sc1
    buffer_load_dwordx4 v[196:199], v11, s[16:19], s32 offen offset:1024 sc1
    s_add_u32 s32, s32, 3657728
    ds_write_b128 v3, v[32:35] offset:57344
    ds_write_b128 v5, v[20:23] offset:58368
    ds_write_b128 v6, v[36:39] offset:59392
    ds_write_b128 v7, v[24:27] offset:60416
    ds_write_b128 v8, v[40:43] offset:61440
    ds_write_b128 v10, v[28:31] offset:62464
    ds_write_b128 v116, v[44:47] offset:63488
    s_waitcnt vmcnt(13)
    v_mfma_f32_32x32x16_bf16 v[80:95], v[120:123], v[48:51], 0
    v_mfma_f32_32x32x16_bf16 v[96:111], v[124:127], v[48:51], 0
    s_waitcnt vmcnt(12)
    v_mfma_f32_32x32x16_bf16 v[80:95], v[128:131], v[52:55], v[80:95]
    v_mfma_f32_32x32x16_bf16 v[96:111], v[132:135], v[52:55], v[96:111]
    s_waitcnt vmcnt(11)
    v_mfma_f32_32x32x16_bf16 v[80:95], v[136:139], v[56:59], v[80:95]
    v_mfma_f32_32x32x16_bf16 v[96:111], v[140:143], v[56:59], v[96:111]
    s_waitcnt vmcnt(10)
    v_mfma_f32_32x32x16_bf16 v[80:95], v[68:71], v[60:63], v[80:95]
    v_mfma_f32_32x32x16_bf16 v[96:111], v[72:75], v[60:63], v[96:111]
    s_waitcnt vmcnt(9)
    v_mfma_f32_32x32x16_bf16 v[80:95], v[200:203], v[64:67], v[80:95]
    v_mfma_f32_32x32x16_bf16 v[96:111], v[204:207], v[64:67], v[96:111]
    s_waitcnt vmcnt(8)
    v_mfma_f32_32x32x16_bf16 v[80:95], v[208:211], v[76:79], v[80:95]
    v_mfma_f32_32x32x16_bf16 v[96:111], v[212:215], v[76:79], v[96:111]
    s_waitcnt vmcnt(7)
    v_mfma_f32_32x32x16_bf16 v[80:95], v[216:219], v[168:171], v[80:95]
    v_mfma_f32_32x32x16_bf16 v[96:111], v[220:223], v[168:171], v[96:111]
    s_waitcnt vmcnt(6)
    v_mfma_f32_32x32x16_bf16 v[80:95], v[224:227], v[172:175], v[80:95]
    v_mfma_f32_32x32x16_bf16 v[96:111], v[228:231], v[172:175], v[96:111]
    s_waitcnt vmcnt(5)
    v_mfma_f32_32x32x16_bf16 v[80:95], v[232:235], v[176:179], v[80:95]
    v_mfma_f32_32x32x16_bf16 v[96:111], v[236:239], v[176:179], v[96:111]
    s_waitcnt lgkmcnt(0)
    s_barrier
    s_waitcnt vmcnt(4)
    v_mfma_f32_32x32x16_bf16 v[80:95], v[240:243], v[180:183], v[80:95]
    v_mfma_f32_32x32x16_bf16 v[96:111], v[244:247], v[180:183], v[96:111]
    s_waitcnt vmcnt(3)
    v_mfma_f32_32x32x16_bf16 v[80:95], v[248:251], v[184:187], v[80:95]
    v_mfma_f32_32x32x16_bf16 v[96:111], v[252:255], v[184:187], v[96:111]
    s_waitcnt vmcnt(2)
    v_mfma_f32_32x32x16_bf16 v[80:95], v[144:147], v[188:191], v[80:95]
    v_mfma_f32_32x32x16_bf16 v[96:111], v[148:151], v[188:191], v[96:111]
    s_waitcnt vmcnt(1)
    v_mfma_f32_32x32x16_bf16 v[80:95], v[152:155], v[192:195], v[80:95]
    v_mfma_f32_32x32x16_bf16 v[96:111], v[156:159], v[192:195], v[96:111]
    s_waitcnt vmcnt(0)
    v_mfma_f32_32x32x16_bf16 v[80:95], v[160:163], v[196:199], v[80:95]
    v_mfma_f32_32x32x16_bf16 v[96:111], v[164:167], v[196:199], v[96:111]
    s_nop 11
    ds_write_b128 v3, v[96:99] offset:0
    ds_write_b128 v6, v[100:103] offset:2048
    ds_write_b128 v8, v[104:107] offset:4096
    ds_write_b128 v116, v[108:111] offset:6144
    ds_write_b128 v5, v[84:87] offset:1024
    ds_write_b128 v7, v[88:91] offset:3072
    ds_write_b128 v10, v[92:95] offset:5120
    ds_read_b128 v[20:23], v2 offset:57344
    ds_read_b128 v[24:27], v2 offset:58368
    ds_read_b128 v[28:31], v2 offset:59392
    ds_read_b128 v[32:35], v2 offset:60416
    ds_read_b128 v[36:39], v2 offset:61440
    ds_read_b128 v[40:43], v2 offset:62464
    ds_read_b128 v[44:47], v2 offset:63488
    v_lshlrev_b32 v12, 16, v112
    v_and_b32 v13, 0xffff0000, v112
    v_lshlrev_b32 v14, 16, v113
    v_and_b32 v15, 0xffff0000, v113
    v_pk_add_f32 v[16:17], v[16:17], v[12:13]
    v_pk_add_f32 v[18:19], v[18:19], v[14:15]
    s_waitcnt lgkmcnt(6)
    v_pk_add_f32 v[16:17], v[16:17], v[20:21]
    v_pk_add_f32 v[18:19], v[18:19], v[22:23]
    s_waitcnt lgkmcnt(5)
    v_pk_add_f32 v[16:17], v[16:17], v[24:25]
    v_pk_add_f32 v[18:19], v[18:19], v[26:27]
    s_waitcnt lgkmcnt(4)
    v_pk_add_f32 v[16:17], v[16:17], v[28:29]
    v_pk_add_f32 v[18:19], v[18:19], v[30:31]
    s_waitcnt lgkmcnt(3)
    v_pk_add_f32 v[16:17], v[16:17], v[32:33]
    v_pk_add_f32 v[18:19], v[18:19], v[34:35]
    s_waitcnt lgkmcnt(2)
    v_pk_add_f32 v[16:17], v[16:17], v[36:37]
    v_pk_add_f32 v[18:19], v[18:19], v[38:39]
    s_waitcnt lgkmcnt(1)
    v_pk_add_f32 v[16:17], v[16:17], v[40:41]
    v_pk_add_f32 v[18:19], v[18:19], v[42:43]
    s_waitcnt lgkmcnt(0)
    v_pk_add_f32 v[16:17], v[16:17], v[44:45]
    v_pk_add_f32 v[18:19], v[18:19], v[46:47]
    v_cvt_pk_bf16_f32 v12, v16, v17
    v_cvt_pk_bf16_f32 v13, v18, v19
    s_mov_b32 s3, 0
    buffer_store_dwordx2 v[12:13], v117, s[52:55], s3 offen
    s_barrier
    ds_read_b128 v[84:87], v2 offset:0
    ds_read_b128 v[88:91], v2 offset:1024
    ds_read_b128 v[92:95], v2 offset:2048
    ds_read_b128 v[96:99], v2 offset:3072
    ds_read_b128 v[100:103], v2 offset:4096
    ds_read_b128 v[104:107], v2 offset:5120
    ds_read_b128 v[108:111], v2 offset:6144
    v_lshlrev_b32 v12, 16, v114
    v_and_b32 v13, 0xffff0000, v114
    v_lshlrev_b32 v14, 16, v115
    v_and_b32 v15, 0xffff0000, v115
    v_pk_add_f32 v[80:81], v[80:81], v[12:13]
    v_pk_add_f32 v[82:83], v[82:83], v[14:15]
    s_waitcnt lgkmcnt(6)
    v_pk_add_f32 v[80:81], v[80:81], v[84:85]
    v_pk_add_f32 v[82:83], v[82:83], v[86:87]
    s_waitcnt lgkmcnt(5)
    v_pk_add_f32 v[80:81], v[80:81], v[88:89]
    v_pk_add_f32 v[82:83], v[82:83], v[90:91]
    s_waitcnt lgkmcnt(4)
    v_pk_add_f32 v[80:81], v[80:81], v[92:93]
    v_pk_add_f32 v[82:83], v[82:83], v[94:95]
    s_waitcnt lgkmcnt(3)
    v_pk_add_f32 v[80:81], v[80:81], v[96:97]
    v_pk_add_f32 v[82:83], v[82:83], v[98:99]
    s_waitcnt lgkmcnt(2)
    v_pk_add_f32 v[80:81], v[80:81], v[100:101]
    v_pk_add_f32 v[82:83], v[82:83], v[102:103]
    s_waitcnt lgkmcnt(1)
    v_pk_add_f32 v[80:81], v[80:81], v[104:105]
    v_pk_add_f32 v[82:83], v[82:83], v[106:107]
    s_waitcnt lgkmcnt(0)
    v_pk_add_f32 v[80:81], v[80:81], v[108:109]
    v_pk_add_f32 v[82:83], v[82:83], v[110:111]
    v_cvt_pk_bf16_f32 v12, v80, v81
    v_cvt_pk_bf16_f32 v13, v82, v83
    s_mov_b32 s3, 917504
    buffer_store_dwordx2 v[12:13], v117, s[52:55], s3 offen
    s_endpgm
La_help:
    s_lshl_b32 s3, s2, 6
    v_lshrrev_b32 v3, 3, v0
    v_add_u32 v3, s3, v3
    v_and_b32 v5, 0x701, v3
    v_and_b32 v6, 0x7e, v3
    v_lshl_add_u32 v5, v6, 1, v5
    v_bfe_u32 v6, v3, 7, 1
    v_lshl_add_u32 v5, v6, 1, v5
    v_mul_u32_u24 v5, 896, v5
    v_lshl_add_u32 v5, v4, 4, v5
    s_xor_b32 s3, s2, 31
    s_or_b32 s3, s3, s36
    s_waitcnt lgkmcnt(0)
    s_mov_b32 s52, s48
    s_mov_b32 s53, s49
    s_mov_b32 s54, 0x100
    s_mov_b32 s55, 0x20000
    s_cmp_lg_u32 s3, 0
    s_cbranch_scc1 La_non
    s_memrealtime s[56:57]
    s_waitcnt lgkmcnt(0)
    s_or_b32 s3, s56, 1
    v_mov_b32 v12, s3
    v_mov_b32 v13, 0
    s_mov_b64 exec, 1
    buffer_atomic_cmpswap v[12:13], v17, s[52:55], 0 offen sc1
    s_mov_b64 exec, -1
La_non:
    s_mov_b32 s28, s4
    s_mov_b32 s29, s5
    s_mov_b32 s30, 0x1c0000
    s_mov_b32 s31, 0x20000
    s_mov_b32 s16, s50
    s_mov_b32 s17, s51
    s_mov_b32 s18, 0x1440000
    s_mov_b32 s19, 0x20000
    buffer_load_dwordx4 v[108:111], v5, s[28:31], 0 offen offset:0
    buffer_load_dwordx4 v[112:115], v5, s[28:31], 0 offen offset:128
    buffer_load_dwordx4 v[116:119], v5, s[28:31], 0 offen offset:256
    buffer_load_dwordx4 v[120:123], v5, s[28:31], 0 offen offset:384
    buffer_load_dwordx4 v[124:127], v5, s[28:31], 0 offen offset:512
    buffer_load_dwordx4 v[128:131], v5, s[28:31], 0 offen offset:640
    buffer_load_dwordx4 v[132:135], v5, s[28:31], 0 offen offset:768
    v_lshlrev_b32 v6, 3, v3
    s_mov_b32 s56, 0xc40000
    s_getpc_b64 s[20:21]
La_pc:
    s_sub_u32 s20, s20, La_pc-sequential_preLN__ssm_conv_h3__geglu_ffn__prompt_kernel
    s_subb_u32 s21, s21, 0
    s_lshr_b32 s3, s2, 3
    s_lshl_b32 s3, s3, 3
    s_add_u32 s3, s3, s36
    v_and_b32 v13, 7, v1
    v_lshlrev_b32 v13, 5, v13
    v_add_lshl_u32 v13, s3, v13, 7
    v_min_u32 v13, Lcode_end-sequential_preLN__ssm_conv_h3__geglu_ffn__prompt_kernel-4, v13
    v_mov_b32 v15, s21
    v_add_co_u32 v14, vcc, s20, v13
    s_nop 1
    v_addc_co_u32 v15, vcc, 0, v15, vcc
    global_load_dword v27, v[14:15], off
    s_mov_b32 s3, 0x3f803f80
    v_mov_b32 v100, 0
    v_mov_b32 v101, 0
    v_mov_b32 v102, 0
    v_mov_b32 v103, 0
    s_waitcnt vmcnt(7)
    buffer_load_dword v12, v17, s[52:55], 0 offen sc1
    v_dot2c_f32_bf16 v100, s3, v108
    v_dot2c_f32_bf16 v102, v108, v108
    v_dot2c_f32_bf16 v101, s3, v109
    v_dot2c_f32_bf16 v103, v109, v109
    v_dot2c_f32_bf16 v100, s3, v110
    v_dot2c_f32_bf16 v102, v110, v110
    v_dot2c_f32_bf16 v101, s3, v111
    v_dot2c_f32_bf16 v103, v111, v111
    s_waitcnt vmcnt(7)
    v_dot2c_f32_bf16 v100, s3, v112
    v_dot2c_f32_bf16 v102, v112, v112
    v_dot2c_f32_bf16 v101, s3, v113
    v_dot2c_f32_bf16 v103, v113, v113
    v_dot2c_f32_bf16 v100, s3, v114
    v_dot2c_f32_bf16 v102, v114, v114
    v_dot2c_f32_bf16 v101, s3, v115
    v_dot2c_f32_bf16 v103, v115, v115
    s_waitcnt vmcnt(6)
    v_dot2c_f32_bf16 v100, s3, v116
    v_dot2c_f32_bf16 v102, v116, v116
    v_dot2c_f32_bf16 v101, s3, v117
    v_dot2c_f32_bf16 v103, v117, v117
    v_dot2c_f32_bf16 v100, s3, v118
    v_dot2c_f32_bf16 v102, v118, v118
    v_dot2c_f32_bf16 v101, s3, v119
    v_dot2c_f32_bf16 v103, v119, v119
    s_waitcnt vmcnt(5)
    v_dot2c_f32_bf16 v100, s3, v120
    v_dot2c_f32_bf16 v102, v120, v120
    v_dot2c_f32_bf16 v101, s3, v121
    v_dot2c_f32_bf16 v103, v121, v121
    v_dot2c_f32_bf16 v100, s3, v122
    v_dot2c_f32_bf16 v102, v122, v122
    v_dot2c_f32_bf16 v101, s3, v123
    v_dot2c_f32_bf16 v103, v123, v123
    s_waitcnt vmcnt(4)
    v_dot2c_f32_bf16 v100, s3, v124
    v_dot2c_f32_bf16 v102, v124, v124
    v_dot2c_f32_bf16 v101, s3, v125
    v_dot2c_f32_bf16 v103, v125, v125
    v_dot2c_f32_bf16 v100, s3, v126
    v_dot2c_f32_bf16 v102, v126, v126
    v_dot2c_f32_bf16 v101, s3, v127
    v_dot2c_f32_bf16 v103, v127, v127
    s_waitcnt vmcnt(3)
    v_dot2c_f32_bf16 v100, s3, v128
    v_dot2c_f32_bf16 v102, v128, v128
    v_dot2c_f32_bf16 v101, s3, v129
    v_dot2c_f32_bf16 v103, v129, v129
    v_dot2c_f32_bf16 v100, s3, v130
    v_dot2c_f32_bf16 v102, v130, v130
    v_dot2c_f32_bf16 v101, s3, v131
    v_dot2c_f32_bf16 v103, v131, v131
    s_waitcnt vmcnt(2)
    v_dot2c_f32_bf16 v100, s3, v132
    v_dot2c_f32_bf16 v102, v132, v132
    v_dot2c_f32_bf16 v101, s3, v133
    v_dot2c_f32_bf16 v103, v133, v133
    v_dot2c_f32_bf16 v100, s3, v134
    v_dot2c_f32_bf16 v102, v134, v134
    v_dot2c_f32_bf16 v101, s3, v135
    v_dot2c_f32_bf16 v103, v135, v135
    s_nop 1
    v_add_f32 v100, v100, v101
    v_add_f32 v102, v102, v103
    s_nop 0
    v_add_f32_dpp v100, v100, v100 quad_perm:[1,0,3,2] row_mask:0xf bank_mask:0xf
    v_add_f32_dpp v102, v102, v102 quad_perm:[1,0,3,2] row_mask:0xf bank_mask:0xf
    s_nop 0
    v_add_f32_dpp v100, v100, v100 quad_perm:[2,3,0,1] row_mask:0xf bank_mask:0xf
    v_add_f32_dpp v102, v102, v102 quad_perm:[2,3,0,1] row_mask:0xf bank_mask:0xf
    s_nop 0
    v_add_f32_dpp v100, v100, v100 row_half_mirror row_mask:0xf bank_mask:0xf
    v_add_f32_dpp v102, v102, v102 row_half_mirror row_mask:0xf bank_mask:0xf
    v_mul_f32 v100, 0x3b124925, v100
    v_mul_f32 v102, 0x3b124925, v102
    v_fma_f32 v102, -v100, v100, v102
    v_max_f32 v102, 0, v102
    v_cvt_pk_bf16_f32 v102, v102, v102
    v_and_b32 v102, 0xffff0000, v102
    v_add_f32 v102, 0x3727c5ac, v102
    v_cvt_pk_bf16_f32 v102, v102, v102
    v_and_b32 v102, 0xffff0000, v102
    v_sqrt_f32 v102, v102
    s_waitcnt vmcnt(0)
    s_mov_b32 s59, 0
La_hnc:
    v_readfirstlane_b32 s63, v12
    s_nop 0
    s_cmp_lg_u32 s63, 0
    s_cbranch_scc1 La_hngo
    s_cmp_gt_u32 s59, 262144
    s_cbranch_scc1 La_hngo
    buffer_load_dword v12, v17, s[52:55], 0 offen sc1
    s_add_u32 s59, s59, 1
    s_waitcnt vmcnt(0)
    s_branch La_hnc
La_hngo:
    v_cvt_pk_bf16_f32 v100, v100, v102
    v_mov_b32 v101, s63
    v_cmp_eq_u32 vcc, 0, v4
    s_nop 0
    s_and_saveexec_b64 s[32:33], vcc
    buffer_store_dwordx2 v[100:101], v6, s[16:19], s56 offen sc1
    s_mov_b64 exec, s[32:33]
    s_barrier
    s_lshl_b32 s3, s2, 3
    s_add_u32 s3, s3, s36
    v_min_u32 v13, 7, v1
    v_lshlrev_b32 v13, 8, v13
    v_add_lshl_u32 v13, s3, v13, 7
    v_add_u32 v13, 0xcd0000, v13
    s_lshl_b32 s3, s3, 6
    s_add_u32 s3, s3, 0xc4c000
    v_mov_b32 v14, s3
    v_cmp_gt_u32 vcc, 16, v1
    s_nop 1
    v_cndmask_b32 v13, v14, v13, vcc
    buffer_load_dword v28, v13, s[16:19], 0 offen
    s_cmp_lt_u32 s2, 4
    s_cbranch_scc1 Lf_csd
    s_bfe_u32 s8, s2, 0x10001
    s_and_b32 s9, s2, 1
    s_mul_i32 s9, s9, 7
    s_lshr_b32 s3, s2, 2
    s_sub_u32 s3, s3, 1
    s_add_u32 s9, s9, s3
    v_lshrrev_b32 v24, 4, v0
    v_and_b32 v25, 15, v0
    v_mul_u32_u24 v3, 3584, v24
    v_lshl_add_u32 v3, v25, 4, v3
    s_lshl_b32 s10, s9, 8
    s_cmp_eq_u32 s8, 0
    s_cselect_b32 s24, s40, s42
    s_cselect_b32 s25, s41, s43
    s_mov_b32 s26, 0x188000
    s_mov_b32 s27, 0x20000
    buffer_load_dwordx4 v[32:35], v3, s[24:27], s10 offen
    s_add_u32 s10, s10, 114688
    buffer_load_dwordx4 v[36:39], v3, s[24:27], s10 offen
    s_add_u32 s10, s10, 114688
    buffer_load_dwordx4 v[40:43], v3, s[24:27], s10 offen
    s_add_u32 s10, s10, 114688
    buffer_load_dwordx4 v[44:47], v3, s[24:27], s10 offen
    s_add_u32 s10, s10, 114688
    buffer_load_dwordx4 v[48:51], v3, s[24:27], s10 offen
    s_add_u32 s10, s10, 114688
    buffer_load_dwordx4 v[52:55], v3, s[24:27], s10 offen
    s_add_u32 s10, s10, 114688
    buffer_load_dwordx4 v[56:59], v3, s[24:27], s10 offen
    s_add_u32 s10, s10, 114688
    buffer_load_dwordx4 v[60:63], v3, s[24:27], s10 offen
    s_add_u32 s10, s10, 114688
    buffer_load_dwordx4 v[64:67], v3, s[24:27], s10 offen
    s_add_u32 s10, s10, 114688
    buffer_load_dwordx4 v[68:71], v3, s[24:27], s10 offen
    s_add_u32 s10, s10, 114688
    buffer_load_dwordx4 v[72:75], v3, s[24:27], s10 offen
    s_add_u32 s10, s10, 114688
    buffer_load_dwordx4 v[76:79], v3, s[24:27], s10 offen
    s_add_u32 s10, s10, 114688
    buffer_load_dwordx4 v[80:83], v3, s[24:27], s10 offen
    s_add_u32 s10, s10, 114688
    buffer_load_dwordx4 v[84:87], v3, s[24:27], s10 offen
    s_add_u32 s10, s10, 114688
    s_mov_b32 s12, 0x00003f80
    s_mov_b32 s13, 0x3f800000
    v_mov_b32 v8, 0
    v_mov_b32 v9, 0
    v_mov_b32 v10, 0
    v_mov_b32 v11, 0
    v_mov_b32 v12, 0
    v_mov_b32 v13, 0
    v_mov_b32 v14, 0
    v_mov_b32 v15, 0
    v_lshlrev_b32 v4, 5, v0
    s_waitcnt vmcnt(13)
    v_dot2c_f32_bf16 v8, s12, v32
    v_dot2c_f32_bf16 v9, s13, v32
    v_dot2c_f32_bf16 v10, s12, v33
    v_dot2c_f32_bf16 v11, s13, v33
    v_dot2c_f32_bf16 v12, s12, v34
    v_dot2c_f32_bf16 v13, s13, v34
    v_dot2c_f32_bf16 v14, s12, v35
    v_dot2c_f32_bf16 v15, s13, v35
    s_waitcnt vmcnt(12)
    v_dot2c_f32_bf16 v8, s12, v36
    v_dot2c_f32_bf16 v9, s13, v36
    v_dot2c_f32_bf16 v10, s12, v37
    v_dot2c_f32_bf16 v11, s13, v37
    v_dot2c_f32_bf16 v12, s12, v38
    v_dot2c_f32_bf16 v13, s13, v38
    v_dot2c_f32_bf16 v14, s12, v39
    v_dot2c_f32_bf16 v15, s13, v39
    s_waitcnt vmcnt(11)
    v_dot2c_f32_bf16 v8, s12, v40
    v_dot2c_f32_bf16 v9, s13, v40
    v_dot2c_f32_bf16 v10, s12, v41
    v_dot2c_f32_bf16 v11, s13, v41
    v_dot2c_f32_bf16 v12, s12, v42
    v_dot2c_f32_bf16 v13, s13, v42
    v_dot2c_f32_bf16 v14, s12, v43
    v_dot2c_f32_bf16 v15, s13, v43
    s_waitcnt vmcnt(10)
    v_dot2c_f32_bf16 v8, s12, v44
    v_dot2c_f32_bf16 v9, s13, v44
    v_dot2c_f32_bf16 v10, s12, v45
    v_dot2c_f32_bf16 v11, s13, v45
    v_dot2c_f32_bf16 v12, s12, v46
    v_dot2c_f32_bf16 v13, s13, v46
    v_dot2c_f32_bf16 v14, s12, v47
    v_dot2c_f32_bf16 v15, s13, v47
    s_waitcnt vmcnt(9)
    v_dot2c_f32_bf16 v8, s12, v48
    v_dot2c_f32_bf16 v9, s13, v48
    v_dot2c_f32_bf16 v10, s12, v49
    v_dot2c_f32_bf16 v11, s13, v49
    v_dot2c_f32_bf16 v12, s12, v50
    v_dot2c_f32_bf16 v13, s13, v50
    v_dot2c_f32_bf16 v14, s12, v51
    v_dot2c_f32_bf16 v15, s13, v51
    s_waitcnt vmcnt(8)
    v_dot2c_f32_bf16 v8, s12, v52
    v_dot2c_f32_bf16 v9, s13, v52
    v_dot2c_f32_bf16 v10, s12, v53
    v_dot2c_f32_bf16 v11, s13, v53
    v_dot2c_f32_bf16 v12, s12, v54
    v_dot2c_f32_bf16 v13, s13, v54
    v_dot2c_f32_bf16 v14, s12, v55
    v_dot2c_f32_bf16 v15, s13, v55
    s_waitcnt vmcnt(7)
    v_dot2c_f32_bf16 v8, s12, v56
    v_dot2c_f32_bf16 v9, s13, v56
    v_dot2c_f32_bf16 v10, s12, v57
    v_dot2c_f32_bf16 v11, s13, v57
    v_dot2c_f32_bf16 v12, s12, v58
    v_dot2c_f32_bf16 v13, s13, v58
    v_dot2c_f32_bf16 v14, s12, v59
    v_dot2c_f32_bf16 v15, s13, v59
    s_waitcnt vmcnt(6)
    v_dot2c_f32_bf16 v8, s12, v60
    v_dot2c_f32_bf16 v9, s13, v60
    v_dot2c_f32_bf16 v10, s12, v61
    v_dot2c_f32_bf16 v11, s13, v61
    v_dot2c_f32_bf16 v12, s12, v62
    v_dot2c_f32_bf16 v13, s13, v62
    v_dot2c_f32_bf16 v14, s12, v63
    v_dot2c_f32_bf16 v15, s13, v63
    s_waitcnt vmcnt(5)
    v_dot2c_f32_bf16 v8, s12, v64
    v_dot2c_f32_bf16 v9, s13, v64
    v_dot2c_f32_bf16 v10, s12, v65
    v_dot2c_f32_bf16 v11, s13, v65
    v_dot2c_f32_bf16 v12, s12, v66
    v_dot2c_f32_bf16 v13, s13, v66
    v_dot2c_f32_bf16 v14, s12, v67
    v_dot2c_f32_bf16 v15, s13, v67
    s_waitcnt vmcnt(4)
    v_dot2c_f32_bf16 v8, s12, v68
    v_dot2c_f32_bf16 v9, s13, v68
    v_dot2c_f32_bf16 v10, s12, v69
    v_dot2c_f32_bf16 v11, s13, v69
    v_dot2c_f32_bf16 v12, s12, v70
    v_dot2c_f32_bf16 v13, s13, v70
    v_dot2c_f32_bf16 v14, s12, v71
    v_dot2c_f32_bf16 v15, s13, v71
    s_waitcnt vmcnt(3)
    v_dot2c_f32_bf16 v8, s12, v72
    v_dot2c_f32_bf16 v9, s13, v72
    v_dot2c_f32_bf16 v10, s12, v73
    v_dot2c_f32_bf16 v11, s13, v73
    v_dot2c_f32_bf16 v12, s12, v74
    v_dot2c_f32_bf16 v13, s13, v74
    v_dot2c_f32_bf16 v14, s12, v75
    v_dot2c_f32_bf16 v15, s13, v75
    s_waitcnt vmcnt(2)
    v_dot2c_f32_bf16 v8, s12, v76
    v_dot2c_f32_bf16 v9, s13, v76
    v_dot2c_f32_bf16 v10, s12, v77
    v_dot2c_f32_bf16 v11, s13, v77
    v_dot2c_f32_bf16 v12, s12, v78
    v_dot2c_f32_bf16 v13, s13, v78
    v_dot2c_f32_bf16 v14, s12, v79
    v_dot2c_f32_bf16 v15, s13, v79
    s_waitcnt vmcnt(1)
    v_dot2c_f32_bf16 v8, s12, v80
    v_dot2c_f32_bf16 v9, s13, v80
    v_dot2c_f32_bf16 v10, s12, v81
    v_dot2c_f32_bf16 v11, s13, v81
    v_dot2c_f32_bf16 v12, s12, v82
    v_dot2c_f32_bf16 v13, s13, v82
    v_dot2c_f32_bf16 v14, s12, v83
    v_dot2c_f32_bf16 v15, s13, v83
    s_waitcnt vmcnt(0)
    v_dot2c_f32_bf16 v8, s12, v84
    v_dot2c_f32_bf16 v9, s13, v84
    v_dot2c_f32_bf16 v10, s12, v85
    v_dot2c_f32_bf16 v11, s13, v85
    v_dot2c_f32_bf16 v12, s12, v86
    v_dot2c_f32_bf16 v13, s13, v86
    v_dot2c_f32_bf16 v14, s12, v87
    v_dot2c_f32_bf16 v15, s13, v87
    ds_write_b128 v4, v[8:11]
    s_nop 1
    ds_write_b128 v4, v[12:15] offset:16
    s_waitcnt lgkmcnt(0)
    s_barrier
    s_cmp_ge_u32 s36, 2
    s_cbranch_scc1 Lf_csd
    v_lshlrev_b32 v4, 2, v0
    ds_read2st64_b32 v[32:33], v4 offset0:0 offset1:2
    ds_read2st64_b32 v[34:35], v4 offset0:4 offset1:6
    ds_read2st64_b32 v[36:37], v4 offset0:8 offset1:10
    ds_read2st64_b32 v[38:39], v4 offset0:12 offset1:14
    ds_read2st64_b32 v[40:41], v4 offset0:16 offset1:18
    ds_read2st64_b32 v[42:43], v4 offset0:20 offset1:22
    ds_read2st64_b32 v[44:45], v4 offset0:24 offset1:26
    ds_read2st64_b32 v[46:47], v4 offset0:28 offset1:30
    s_waitcnt lgkmcnt(0)
    ds_read2st64_b32 v[48:49], v4 offset0:32 offset1:34
    ds_read2st64_b32 v[50:51], v4 offset0:36 offset1:38
    ds_read2st64_b32 v[52:53], v4 offset0:40 offset1:42
    ds_read2st64_b32 v[54:55], v4 offset0:44 offset1:46
    ds_read2st64_b32 v[56:57], v4 offset0:48 offset1:50
    ds_read2st64_b32 v[58:59], v4 offset0:52 offset1:54
    ds_read2st64_b32 v[60:61], v4 offset0:56 offset1:58
    ds_read2st64_b32 v[62:63], v4 offset0:60 offset1:62
    s_lshl_b32 s3, s9, 3
    v_add_u32 v5, s3, v24
    v_lshlrev_b32 v5, 5, v5
    v_and_b32 v6, 3, v25
    v_and_b32 v7, 4, v25
    v_lshl_add_u32 v6, v7, 1, v6
    v_and_b32 v7, 8, v25
    v_lshrrev_b32 v7, 1, v7
    v_add3_u32 v5, v5, v6, v7
    s_lshl_b32 s3, s8, 4
    v_add_lshl_u32 v5, s3, v5, 3
    s_mov_b32 s11, 0xc54000
    s_waitcnt lgkmcnt(0)
    v_pk_add_f32 v[32:33], v[32:33], v[48:49]
    v_pk_add_f32 v[34:35], v[34:35], v[50:51]
    v_pk_add_f32 v[36:37], v[36:37], v[52:53]
    v_pk_add_f32 v[38:39], v[38:39], v[54:55]
    v_pk_add_f32 v[40:41], v[40:41], v[56:57]
    v_pk_add_f32 v[42:43], v[42:43], v[58:59]
    v_pk_add_f32 v[44:45], v[44:45], v[60:61]
    v_pk_add_f32 v[46:47], v[46:47], v[62:63]
    v_pk_add_f32 v[32:33], v[32:33], v[40:41]
    v_pk_add_f32 v[34:35], v[34:35], v[42:43]
    v_pk_add_f32 v[36:37], v[36:37], v[44:45]
    v_pk_add_f32 v[38:39], v[38:39], v[46:47]
    v_pk_add_f32 v[32:33], v[32:33], v[36:37]
    v_pk_add_f32 v[34:35], v[34:35], v[38:39]
    v_pk_add_f32 v[32:33], v[32:33], v[34:35]
    v_add_f32 v32, v32, v33
    v_cvt_pk_bf16_f32 v33, v32, v32
    v_and_b32 v33, 0xffff0000, v33
    v_sub_f32 v34, v32, v33
    v_cvt_pk_bf16_f32 v32, v33, v34
    v_mov_b32 v33, s63
    buffer_store_dwordx2 v[32:33], v5, s[16:19], s11 offen sc1
Lf_csd:
    s_barrier
    s_cmp_lt_u32 s2, 16
    s_cbranch_scc1 Lf_n3
    s_lshl_b32 s3, s2, 3
    s_add_u32 s3, s3, s36
    v_min_u32 v13, 55, v1
    v_lshlrev_b32 v13, 7, v13
    v_add_lshl_u32 v13, s3, v13, 7
    s_mov_b32 s3, 0xd1c000
    buffer_load_dword v29, v13, s[16:19], s3 offen
    s_waitcnt vmcnt(0)
Lf_n3:
    s_lshr_b32 s57, s2, 2
    s_lshl_b32 s57, s57, 15
    s_add_u32 s57, s57, 0xcd0000
    v_min_u32 v18, 27, v1
    v_lshrrev_b32 v20, 2, v18
    v_and_b32 v18, 3, v18
    v_lshl_add_u32 v18, v20, 5, v18
    s_lshl_b32 s3, s36, 2
    v_add_lshl_u32 v18, s3, v18, 7
    v_lshrrev_b32 v3, 3, v1
    v_and_b32 v4, 7, v1
    v_lshlrev_b32 v5, 4, v4
    v_lshl_add_u32 v5, v3, 12, v5
    s_lshl_b32 s14, s36, 15
    s_lshl_b32 s15, s2, 7
    s_add_u32 s14, s14, s15
    s_add_u32 s14, s14, 0x380000
    v_lshrrev_b32 v6, 5, v0
    v_lshlrev_b32 v6, 8, v6
    v_lshl_add_u32 v6, v4, 5, v6
    v_and_b32 v7, 16, v1
    v_add_u32 v6, v6, v7
    v_lshlrev_b32 v7, 2, v1
    v_lshlrev_b32 v8, 3, v1
    s_lshl_b32 s15, s2, 9
    s_add_u32 s15, s15, 0xc4c000
    s_mov_b32 s59, 0
Lf_hp:
    buffer_load_dword v22, v18, s[16:19], s57 offen sc1
    s_add_u32 s59, s59, 1
    s_waitcnt vmcnt(0)
    v_cmp_ne_u32 vcc, s63, v22
    s_cmp_gt_u32 s59, 262144
    s_cbranch_scc1 Lf_hpgo
    s_cbranch_vccz Lf_hpgo
    s_sleep 1
    s_branch Lf_hp
Lf_hpgo:
    buffer_load_dwordx4 v[16:19], v5, s[16:19], s14 offen sc1
    s_add_u32 s14, s14, 262144
    buffer_load_dwordx4 v[20:23], v5, s[16:19], s14 offen sc1
    s_add_u32 s14, s14, 262144
    buffer_load_dwordx4 v[24:27], v5, s[16:19], s14 offen sc1
    s_add_u32 s14, s14, 262144
    buffer_load_dwordx4 v[28:31], v5, s[16:19], s14 offen sc1
    s_add_u32 s14, s14, 262144
    buffer_load_dwordx4 v[32:35], v5, s[16:19], s14 offen sc1
    s_add_u32 s14, s14, 262144
    buffer_load_dwordx4 v[36:39], v5, s[16:19], s14 offen sc1
    s_add_u32 s14, s14, 262144
    buffer_load_dwordx4 v[40:43], v5, s[16:19], s14 offen sc1
    s_add_u32 s14, s14, 262144
    s_waitcnt vmcnt(6)
    v_lshlrev_b32 v48, 16, v16
    v_and_b32 v49, 0xffff0000, v16
    v_lshlrev_b32 v50, 16, v17
    v_and_b32 v51, 0xffff0000, v17
    v_lshlrev_b32 v52, 16, v18
    v_and_b32 v53, 0xffff0000, v18
    v_lshlrev_b32 v54, 16, v19
    v_and_b32 v55, 0xffff0000, v19
    v_pk_mul_f32 v[72:73], v[48:49], v[48:49]
    v_mov_b64 v[64:65], v[48:49]
    v_pk_mul_f32 v[74:75], v[50:51], v[50:51]
    v_mov_b64 v[66:67], v[50:51]
    v_pk_mul_f32 v[76:77], v[52:53], v[52:53]
    v_mov_b64 v[68:69], v[52:53]
    v_pk_mul_f32 v[78:79], v[54:55], v[54:55]
    v_mov_b64 v[70:71], v[54:55]
    s_waitcnt vmcnt(5)
    v_lshlrev_b32 v48, 16, v20
    v_and_b32 v49, 0xffff0000, v20
    v_lshlrev_b32 v50, 16, v21
    v_and_b32 v51, 0xffff0000, v21
    v_lshlrev_b32 v52, 16, v22
    v_and_b32 v53, 0xffff0000, v22
    v_lshlrev_b32 v54, 16, v23
    v_and_b32 v55, 0xffff0000, v23
    v_pk_fma_f32 v[72:73], v[48:49], v[48:49], v[72:73]
    v_pk_add_f32 v[64:65], v[64:65], v[48:49]
    v_pk_fma_f32 v[74:75], v[50:51], v[50:51], v[74:75]
    v_pk_add_f32 v[66:67], v[66:67], v[50:51]
    v_pk_fma_f32 v[76:77], v[52:53], v[52:53], v[76:77]
    v_pk_add_f32 v[68:69], v[68:69], v[52:53]
    v_pk_fma_f32 v[78:79], v[54:55], v[54:55], v[78:79]
    v_pk_add_f32 v[70:71], v[70:71], v[54:55]
    s_waitcnt vmcnt(4)
    v_lshlrev_b32 v48, 16, v24
    v_and_b32 v49, 0xffff0000, v24
    v_lshlrev_b32 v50, 16, v25
    v_and_b32 v51, 0xffff0000, v25
    v_lshlrev_b32 v52, 16, v26
    v_and_b32 v53, 0xffff0000, v26
    v_lshlrev_b32 v54, 16, v27
    v_and_b32 v55, 0xffff0000, v27
    v_pk_fma_f32 v[72:73], v[48:49], v[48:49], v[72:73]
    v_pk_add_f32 v[64:65], v[64:65], v[48:49]
    v_pk_fma_f32 v[74:75], v[50:51], v[50:51], v[74:75]
    v_pk_add_f32 v[66:67], v[66:67], v[50:51]
    v_pk_fma_f32 v[76:77], v[52:53], v[52:53], v[76:77]
    v_pk_add_f32 v[68:69], v[68:69], v[52:53]
    v_pk_fma_f32 v[78:79], v[54:55], v[54:55], v[78:79]
    v_pk_add_f32 v[70:71], v[70:71], v[54:55]
    s_waitcnt vmcnt(3)
    v_lshlrev_b32 v48, 16, v28
    v_and_b32 v49, 0xffff0000, v28
    v_lshlrev_b32 v50, 16, v29
    v_and_b32 v51, 0xffff0000, v29
    v_lshlrev_b32 v52, 16, v30
    v_and_b32 v53, 0xffff0000, v30
    v_lshlrev_b32 v54, 16, v31
    v_and_b32 v55, 0xffff0000, v31
    v_pk_fma_f32 v[72:73], v[48:49], v[48:49], v[72:73]
    v_pk_add_f32 v[64:65], v[64:65], v[48:49]
    v_pk_fma_f32 v[74:75], v[50:51], v[50:51], v[74:75]
    v_pk_add_f32 v[66:67], v[66:67], v[50:51]
    v_pk_fma_f32 v[76:77], v[52:53], v[52:53], v[76:77]
    v_pk_add_f32 v[68:69], v[68:69], v[52:53]
    v_pk_fma_f32 v[78:79], v[54:55], v[54:55], v[78:79]
    v_pk_add_f32 v[70:71], v[70:71], v[54:55]
    s_waitcnt vmcnt(2)
    v_lshlrev_b32 v48, 16, v32
    v_and_b32 v49, 0xffff0000, v32
    v_lshlrev_b32 v50, 16, v33
    v_and_b32 v51, 0xffff0000, v33
    v_lshlrev_b32 v52, 16, v34
    v_and_b32 v53, 0xffff0000, v34
    v_lshlrev_b32 v54, 16, v35
    v_and_b32 v55, 0xffff0000, v35
    v_pk_fma_f32 v[72:73], v[48:49], v[48:49], v[72:73]
    v_pk_add_f32 v[64:65], v[64:65], v[48:49]
    v_pk_fma_f32 v[74:75], v[50:51], v[50:51], v[74:75]
    v_pk_add_f32 v[66:67], v[66:67], v[50:51]
    v_pk_fma_f32 v[76:77], v[52:53], v[52:53], v[76:77]
    v_pk_add_f32 v[68:69], v[68:69], v[52:53]
    v_pk_fma_f32 v[78:79], v[54:55], v[54:55], v[78:79]
    v_pk_add_f32 v[70:71], v[70:71], v[54:55]
    s_waitcnt vmcnt(1)
    v_lshlrev_b32 v48, 16, v36
    v_and_b32 v49, 0xffff0000, v36
    v_lshlrev_b32 v50, 16, v37
    v_and_b32 v51, 0xffff0000, v37
    v_lshlrev_b32 v52, 16, v38
    v_and_b32 v53, 0xffff0000, v38
    v_lshlrev_b32 v54, 16, v39
    v_and_b32 v55, 0xffff0000, v39
    v_pk_fma_f32 v[72:73], v[48:49], v[48:49], v[72:73]
    v_pk_add_f32 v[64:65], v[64:65], v[48:49]
    v_pk_fma_f32 v[74:75], v[50:51], v[50:51], v[74:75]
    v_pk_add_f32 v[66:67], v[66:67], v[50:51]
    v_pk_fma_f32 v[76:77], v[52:53], v[52:53], v[76:77]
    v_pk_add_f32 v[68:69], v[68:69], v[52:53]
    v_pk_fma_f32 v[78:79], v[54:55], v[54:55], v[78:79]
    v_pk_add_f32 v[70:71], v[70:71], v[54:55]
    s_waitcnt vmcnt(0)
    v_lshlrev_b32 v48, 16, v40
    v_and_b32 v49, 0xffff0000, v40
    v_lshlrev_b32 v50, 16, v41
    v_and_b32 v51, 0xffff0000, v41
    v_lshlrev_b32 v52, 16, v42
    v_and_b32 v53, 0xffff0000, v42
    v_lshlrev_b32 v54, 16, v43
    v_and_b32 v55, 0xffff0000, v43
    v_pk_fma_f32 v[72:73], v[48:49], v[48:49], v[72:73]
    v_pk_add_f32 v[64:65], v[64:65], v[48:49]
    v_pk_fma_f32 v[74:75], v[50:51], v[50:51], v[74:75]
    v_pk_add_f32 v[66:67], v[66:67], v[50:51]
    v_pk_fma_f32 v[76:77], v[52:53], v[52:53], v[76:77]
    v_pk_add_f32 v[68:69], v[68:69], v[52:53]
    v_pk_fma_f32 v[78:79], v[54:55], v[54:55], v[78:79]
    v_pk_add_f32 v[70:71], v[70:71], v[54:55]
    v_permlane32_swap_b32 v64, v72
    v_permlane32_swap_b32 v65, v73
    v_permlane32_swap_b32 v66, v74
    v_permlane32_swap_b32 v67, v75
    v_permlane32_swap_b32 v68, v76
    v_permlane32_swap_b32 v69, v77
    v_permlane32_swap_b32 v70, v78
    v_permlane32_swap_b32 v71, v79
    v_pk_add_f32 v[64:65], v[64:65], v[72:73]
    v_pk_add_f32 v[66:67], v[66:67], v[74:75]
    v_pk_add_f32 v[68:69], v[68:69], v[76:77]
    v_pk_add_f32 v[70:71], v[70:71], v[78:79]
    s_nop 0
    v_permlane16_swap_b32 v64, v68
    v_permlane16_swap_b32 v65, v69
    v_permlane16_swap_b32 v66, v70
    v_permlane16_swap_b32 v67, v71
    v_pk_add_f32 v[64:65], v[64:65], v[68:69]
    v_pk_add_f32 v[66:67], v[66:67], v[70:71]
    s_nop 0
    v_add_f32_dpp v64, v64, v64 row_ror:8 row_mask:0xf bank_mask:0xf
    v_add_f32_dpp v65, v65, v65 row_ror:8 row_mask:0xf bank_mask:0xf
    v_add_f32_dpp v66, v66, v66 row_ror:8 row_mask:0xf bank_mask:0xf
    v_add_f32_dpp v67, v67, v67 row_ror:8 row_mask:0xf bank_mask:0xf
    ds_write_b128 v6, v[64:67]
    s_waitcnt lgkmcnt(0)
    s_barrier
    s_cmp_eq_u32 s36, 0
    s_cbranch_scc1 Lf_w0
    s_endpgm
Lf_w0:
    ds_read2st64_b32 v[16:17], v7 offset0:0 offset1:1
    ds_read2st64_b32 v[18:19], v7 offset0:2 offset1:3
    ds_read2st64_b32 v[20:21], v7 offset0:4 offset1:5
    ds_read2st64_b32 v[22:23], v7 offset0:6 offset1:7
    ds_read2st64_b32 v[24:25], v7 offset0:8 offset1:9
    ds_read2st64_b32 v[26:27], v7 offset0:10 offset1:11
    ds_read2st64_b32 v[28:29], v7 offset0:12 offset1:13
    ds_read2st64_b32 v[30:31], v7 offset0:14 offset1:15
    s_waitcnt lgkmcnt(0)
    v_pk_add_f32 v[16:17], v[16:17], v[24:25]
    v_pk_add_f32 v[18:19], v[18:19], v[26:27]
    v_pk_add_f32 v[20:21], v[20:21], v[28:29]
    v_pk_add_f32 v[22:23], v[22:23], v[30:31]
    v_pk_add_f32 v[16:17], v[16:17], v[20:21]
    v_pk_add_f32 v[18:19], v[18:19], v[22:23]
    v_pk_add_f32 v[16:17], v[16:17], v[18:19]
    v_mul_f32 v16, 0xbb124925, v16
    v_mul_f32 v17, 0x3b124925, v17
    v_fma_f32 v17, -v16, v16, v17
    v_max_f32 v17, 0, v17
    v_cvt_pk_bf16_f32 v17, v17, v17
    v_and_b32 v17, 0xffff0000, v17
    v_add_f32 v17, 0x3727c5ac, v17
    v_cvt_pk_bf16_f32 v17, v17, v17
    v_and_b32 v17, 0xffff0000, v17
    v_sqrt_f32 v17, v17
    v_mov_b32 v21, s63
    v_cvt_pk_bf16_f32 v20, v16, v17
    buffer_store_dwordx2 v[20:21], v8, s[16:19], s15 offen sc1
La_end:
    s_endpgm
Lcode_end:
.section .rodata,"a"
.p2align 6
.amdhsa_kernel sequential_preLN__ssm_conv_h3__geglu_ffn__prompt_kernel
  .amdhsa_next_free_vgpr 256
  .amdhsa_next_free_sgpr 96
  .amdhsa_accum_offset 256
  .amdhsa_group_segment_fixed_size 0
  .amdhsa_kernarg_size 104
  .amdhsa_user_sgpr_count 2
  .amdhsa_user_sgpr_kernarg_segment_ptr 1
  .amdhsa_system_sgpr_workgroup_id_x 1
.end_amdhsa_kernel
```
